```python
import torch

def _softmax(x, axis=-1):
    return torch.softmax(x, dim=axis)

def _gelu(x):
    return torch.nn.functional.gelu(x, approximate='tanh')

def _silu(x):
    return torch.nn.functional.silu(x)

def _sigmoid(x):
    return torch.sigmoid(x)

def _layernorm(x, axis=-1, eps=1e-05):
    m = x.mean(dim=axis, keepdim=True)
    v = x.var(dim=axis, keepdim=True, unbiased=False)
    return (x - m) / torch.sqrt(v + eps)

def _scatter_add(tgt, idx, src, axis=0):
    return tgt.clone().index_add_(axis, idx, src)

def _segment_sum(src, seg, n):
    out = torch.zeros((n,) + src.shape[1:], dtype=src.dtype)
    return out.index_add_(0, seg, src)

def _pad(x, pw):
    flat = tuple((v for pair in reversed(pw) for v in pair))
    return torch.nn.functional.pad(x, flat)
kernel_name = 'parallel_sum__memory_aug_recurrent_mem_tr__dense_activation_mish__prompt'

def setup_inputs():

    _w = lambda a: (lambda t: t.to(torch.bfloat16) if t.is_floating_point() else t)(torch.as_tensor(a))

    def _A_setup():
        B, S, Dm = (1, 2048, 512)
        H, Dh = (32, 128)
        M, seg = (8, 32)
        seg = min(seg, S)
        S = S // seg * seg
        return {'x': _w((lambda *s: torch.randn(*s, dtype=torch.bfloat16) * 0.05)(B, S, Dm)), 'mem0': _w((lambda *s: torch.randn(*s, dtype=torch.bfloat16) * 0.2)(B, M, Dm)), 'Wq': _w((lambda *s: torch.randn(*s, dtype=torch.bfloat16) * 1.6)(Dm, H, Dh) * Dm ** (-0.5)), 'Wk': _w((lambda *s: torch.randn(*s, dtype=torch.bfloat16) * 1.6)(Dm, H, Dh) * Dm ** (-0.5)), 'Wv': _w((lambda *s: torch.randn(*s, dtype=torch.bfloat16) * 0.2)(Dm, H, Dh) * Dm ** (-0.5)), 'Wo': _w((lambda *s: torch.randn(*s, dtype=torch.bfloat16) * 0.2)(H, Dh, Dm) * (H * Dh) ** (-0.5)), 'seg_len': seg}
    _A_in = _A_setup()

    def _B_setup():
        B, S, D, F = (1, 2048, 512, 1792)
        return {'x': _w((lambda *s: torch.randn(*s, dtype=torch.bfloat16) * 0.05)(B, S, D)), 'w1': _w((lambda *s: torch.randn(*s, dtype=torch.bfloat16) * 0.8)(D, F) * D ** (-0.5)), 'b1': _w((lambda *s: torch.randn(*s, dtype=torch.bfloat16) * 0.2)(F)), 'w2': _w((lambda *s: torch.randn(*s, dtype=torch.bfloat16) * 0.1)(F, D) * F ** (-0.5))}
    _B_in = _B_setup()
    return {'A_x': _A_in['x'], 'A_mem0': _A_in['mem0'], 'A_Wq': _A_in['Wq'], 'A_Wk': _A_in['Wk'], 'A_Wv': _A_in['Wv'], 'A_Wo': _A_in['Wo'], 'A_seg_len': _A_in['seg_len'], 'B_x': _B_in['x'], 'B_w1': _B_in['w1'], 'B_b1': _B_in['b1'], 'B_w2': _B_in['w2']}

def reference(A_x, A_mem0, A_Wq, A_Wk, A_Wv, A_Wo, A_seg_len, B_x, B_w1, B_b1, B_w2):

    def _A_ref(x, mem0, Wq, Wk, Wv, Wo, seg_len):
        B, S, Dm = x.shape
        H, Dh = (Wq.shape[1], Wq.shape[2])
        M = mem0.shape[1]
        scale = Dh ** (-0.5)
        n_seg = S // seg_len
        L = M + seg_len
        idx = torch.arange(L)
        mask = (idx[:, None] < M) | (idx[:, None] >= idx[None, :])
        mem = mem0
        outs = []
        for s in range(n_seg):
            xs = x[:, s * seg_len:(s + 1) * seg_len, :].clone()
            h = torch.concatenate([mem, xs], axis=1)
            q = torch.einsum('btd,dhe->bhte', h, Wq)
            k = torch.einsum('btd,dhe->bhte', h, Wk)
            v = torch.einsum('btd,dhe->bhte', h, Wv)
            scores = torch.einsum('bhqe,bhke->bhqk', q, k) * scale
            scores = torch.where(mask[None, None], scores, -1000000000.0)
            p = _softmax(scores, axis=-1)
            o = torch.einsum('bhqk,bhke->bhqe', p, v)
            o = torch.einsum('bhte,hed->btd', o, Wo)
            mem = o[:, :M, :].clone()
            outs.append(o[:, M:, :])
        return torch.concatenate(outs, axis=1)

    def _B_ref(x, w1, b1, w2):
        h = torch.einsum('bsd,df->bsf', x, w1) + b1
        sp = torch.log1p(torch.exp(-torch.abs(h))) + torch.where(h > 0, h, torch.zeros_like(h))
        act = h * torch.tanh(sp)
        return torch.einsum('bsf,fd->bsd', act, w2)
    x = A_x
    xn = _layernorm(x, axis=-1)
    return x + _A_ref(xn, A_mem0, A_Wq, A_Wk, A_Wv, A_Wo, A_seg_len) + _B_ref(xn, B_w1, B_b1, B_w2)
```

```asm
; @launch grid=(256,1,1) block=(256,1,1) lds=163840
.amdgcn_target "amdgcn-amd-amdhsa--gfx950"
.text
.globl parallel_sum__memory_aug_recurrent_mem_tr__dense_activation_mish__prompt_kernel
.p2align 8
.type parallel_sum__memory_aug_recurrent_mem_tr__dense_activation_mish__prompt_kernel,@function
parallel_sum__memory_aug_recurrent_mem_tr__dense_activation_mish__prompt_kernel:
    s_cmp_ge_u32 s2, 256
    s_cbranch_scc1 L_end
    s_load_dwordx2 s[4:5], s[0:1], 96
    s_load_dwordx2 s[8:9], s[0:1], 104
    s_getreg_b32 s92, hwreg(HW_REG_XCC_ID, 0, 3)
    s_waitcnt lgkmcnt(0)
    s_mov_b32 s6, 256
    s_mov_b32 s7, 0x20000
    s_mov_b32 s10, 65536
    s_mov_b32 s11, 0x20000
    v_lshrrev_b32 v1, 6, v0
    s_nop 0
    v_readfirstlane_b32 s93, v1
    s_nop 1
    s_cmp_lg_u32 s93, 0
    s_nop 1
    s_cbranch_scc1 L_c1wait
    s_lshl_b32 s94, s2, 8
    v_lshlrev_b32 v2, 2, v0
    v_mov_b32 v3, 0
    buffer_store_dword v3, v2, s[8:11], s94 offen sc1
    s_waitcnt vmcnt(0)
    s_lshl_b32 s94, s92, 5
    v_mov_b32 v4, s94
    v_mov_b32 v5, 1
    s_mov_b64 exec, 1
    buffer_atomic_add v5, v4, s[4:7], 0 offen sc0
    s_waitcnt vmcnt(0)
    v_mov_b32 v9, 0
    ds_write_b32 v9, v5
    s_mov_b64 exec, -1
    s_waitcnt lgkmcnt(0)
L_c1wait:
    s_barrier
    v_mov_b32 v9, 0
    ds_read_b32 v8, v9
    s_waitcnt lgkmcnt(0)
    v_readfirstlane_b32 s89, v8
    s_mov_b32 s88, 0
    s_cmp_lg_u32 s92, 0
    s_nop 2
    s_cbranch_scc1 L_late
    s_cmp_lt_u32 s89, 32
    s_cbranch_scc0 L_late
    s_mov_b32 s90, s89
    s_branch L_chain
L_late:
    s_load_dwordx2 s[4:5], s[0:1], 96
    s_waitcnt lgkmcnt(0)
    s_mov_b32 s6, 256
    s_mov_b32 s7, 0x20000
    v_and_b32 v1, 63, v0
    v_lshlrev_b32 v2, 5, v1
    s_mov_b32 s95, 1000000
L_cpoll:
    buffer_load_dword v3, v2, s[4:7], 0 offen sc1
    s_waitcnt vmcnt(0)
    v_mov_b32 v4, v3
    s_nop 1
    v_add_u32_dpp v4, v4, v4 row_shr:1 row_mask:0xf bank_mask:0xf bound_ctrl:0
    s_nop 1
    v_add_u32_dpp v4, v4, v4 row_shr:2 row_mask:0xf bank_mask:0xf bound_ctrl:0
    s_nop 1
    v_add_u32_dpp v4, v4, v4 row_shr:4 row_mask:0xf bank_mask:0xf bound_ctrl:0
    s_nop 0
    v_readlane_b32 s94, v4, 7
    s_nop 1
    s_cmp_ge_u32 s94, 256
    s_nop 1
    s_cbranch_scc1 L_cdone
    s_sub_u32 s95, s95, 1
    s_cmp_lg_u32 s95, 0
    s_cbranch_scc1 L_cpoll
L_cdone:
    v_cmp_gt_u32 vcc, s92, v1
    s_nop 1
    v_cndmask_b32 v4, 0, v3, vcc
    s_nop 1
    v_add_u32_dpp v4, v4, v4 row_shr:1 row_mask:0xf bank_mask:0xf bound_ctrl:0
    s_nop 1
    v_add_u32_dpp v4, v4, v4 row_shr:2 row_mask:0xf bank_mask:0xf bound_ctrl:0
    s_nop 1
    v_add_u32_dpp v4, v4, v4 row_shr:4 row_mask:0xf bank_mask:0xf bound_ctrl:0
    s_nop 0
    v_readlane_b32 s94, v4, 7
    v_readlane_b32 s95, v3, 0
    s_nop 0
    s_add_u32 s90, s89, s94
    s_cmp_ge_u32 s95, 32
    s_cselect_b32 s91, 1, 0
    s_mov_b32 s88, 1
    s_cmp_ge_u32 s90, 32
    s_cbranch_scc1 L_worker
L_chain:
    s_mov_b32 s24, s90
    s_load_dwordx2 s[60:61], s[0:1], 104
    s_load_dwordx4 s[64:67], s[0:1], 16
    s_load_dwordx4 s[68:71], s[0:1], 32
    s_load_dwordx2 s[72:73], s[0:1], 8
    v_lshrrev_b32 v1, 6, v0
    s_nop 0
    v_readfirstlane_b32 s25, v1
    s_waitcnt lgkmcnt(0)
    s_add_u32 s4, s60, 1048576
    s_addc_u32 s5, s61, 0
    s_mov_b32 s6, 786432
    s_mov_b32 s7, 0x20000
    s_add_u32 s8, s60, 2097152
    s_addc_u32 s9, s61, 0
    s_mov_b32 s10, 24576
    s_mov_b32 s11, 0x20000
    s_add_u32 s12, s60, 8388608
    s_addc_u32 s13, s61, 0
    s_mov_b32 s14, 33554432
    s_mov_b32 s15, 0x20000
    s_add_u32 s16, s60, 41943040
    s_addc_u32 s17, s61, 0
    s_mov_b32 s18, 16777216
    s_mov_b32 s19, 0x20000
    s_add_u32 s40, s60, 0
    s_addc_u32 s41, s61, 0
    s_mov_b32 s42, 65536
    s_mov_b32 s43, 0x20000
    v_and_b32 v134, 63, v0
    v_and_b32 v135, 15, v134
    v_lshrrev_b32 v136, 4, v134
    v_lshlrev_b32 v2, 4, v134
    v_lshlrev_b32 v13, 2, v134
    v_lshlrev_b32 v12, 7, v134
    s_lshl_b32 s34, s25, 11
    v_add_u32 v1, s34, v2
    s_lshl_b32 s34, s25, 12
    s_add_u32 s34, s34, 16384
    v_add_u32 v3, s34, v2
    v_add_u32 v7, 0x10000, v3
    v_add_u32 v8, 0x20000, v3
    v_lshrrev_b32 v137, 2, v135
    s_lshl_b32 s34, s25, 3
    v_add_u32 v137, s34, v137
    v_lshlrev_b32 v137, 13, v137
    v_and_b32 v138, 3, v135
    v_lshlrev_b32 v138, 3, v138
    v_lshl_add_u32 v138, v136, 5, v138
    v_add_u32 v4, v137, v138
    s_lshl_b32 s34, s24, 7
    v_add_u32 v4, s34, v4
    v_bfe_u32 v137, v135, 1, 2
    v_lshlrev_b32 v137, 2, v137
    v_bfe_u32 v140, v135, 3, 1
    v_add_u32 v137, v137, v140
    v_lshlrev_b32 v137, 4, v137
    v_and_b32 v140, 1, v135
    v_lshl_add_u32 v137, v140, 3, v137
    v_and_b32 v138, 1, v136
    v_lshl_add_u32 v137, v138, 2, v137
    s_lshl_b32 s34, s24, 8
    s_and_b32 s35, s25, 1
    s_lshl_b32 s35, s35, 5
    s_add_u32 s35, s35, s34
    v_add_u32 v6, s35, v137
    v_lshlrev_b32 v138, 3, v138
    v_lshrrev_b32 v139, 1, v136
    v_lshl_add_u32 v137, v139, 4, v135
    v_lshl_add_u32 v137, v137, 4, v138
    s_lshr_b32 s35, s25, 1
    s_lshl_b32 s35, s35, 10
    s_and_b32 s36, s25, 1
    s_lshl_b32 s36, s36, 9
    s_add_u32 s35, s35, s36
    s_add_u32 s35, s35, 0
    v_add_u32 v10, s35, v137
    s_lshl_b32 s34, s24, 13
    s_and_b32 s35, s25, 1
    s_lshl_b32 s35, s35, 12
    s_add_u32 s35, s34, s35
    v_add_u32 v5, s35, v2
    s_lshl_b32 s35, s25, 11
    s_add_u32 s59, s34, s35
    s_mov_b32 s46, 0xcccccccc
    s_mov_b32 s47, 0xcccccccc
    s_mov_b32 s48, 0x33333333
    s_mov_b32 s49, 0x33333333
    s_mov_b32 s44, 0xff00ff00
    s_mov_b32 s45, 0xff00ff00
    s_mov_b32 s50, 0x3e0293ee
    v_mov_b32 v11, 0x4444
    v_mov_b32 v137, 0xeeee
    v_cndmask_b32 v11, v11, v137, s[46:47]
    v_mov_b32 v137, 0x3f80
    v_mov_b32 v138, 0x3f800000
    v_and_b32 v139, 1, v135
    v_cmp_eq_u32 vcc, 1, v139
    s_nop 1
    v_cndmask_b32 v137, v137, v138, vcc
    v_lshrrev_b32 v139, 2, v135
    v_cmp_eq_u32 vcc, v139, v136
    s_nop 1
    v_cndmask_b32 v14, 0, v137, vcc
    v_mov_b32 v15, v14
    v_mov_b32 v16, 0
    v_mov_b32 v17, 0
    v_mov_b32 v18, 0
    v_mov_b32 v19, 0
    v_mov_b32 v28, 0
    v_mov_b32 v29, 0
    v_mov_b32 v20, 0x3f803f80
    v_mov_b32 v21, 0x3f803f80
    v_mov_b32 v22, 0x3f803f80
    v_mov_b32 v23, 0x3f803f80
    v_mov_b32 v137, 0x3f80
    v_mov_b32 v138, 0x3f800000
    v_mov_b32 v24, 0
    v_cmp_eq_u32 vcc, 0, v135
    s_nop 1
    v_cndmask_b32 v24, v24, v137, vcc
    v_cmp_eq_u32 vcc, 1, v135
    s_nop 1
    v_cndmask_b32 v24, v24, v138, vcc
    v_mov_b32 v25, 0
    v_cmp_eq_u32 vcc, 2, v135
    s_nop 1
    v_cndmask_b32 v25, v25, v137, vcc
    v_cmp_eq_u32 vcc, 3, v135
    s_nop 1
    v_cndmask_b32 v25, v25, v138, vcc
    v_mov_b32 v26, 0
    v_cmp_eq_u32 vcc, 4, v135
    s_nop 1
    v_cndmask_b32 v26, v26, v137, vcc
    v_cmp_eq_u32 vcc, 5, v135
    s_nop 1
    v_cndmask_b32 v26, v26, v138, vcc
    v_mov_b32 v27, 0
    v_cmp_eq_u32 vcc, 6, v135
    s_nop 1
    v_cndmask_b32 v27, v27, v137, vcc
    v_cmp_eq_u32 vcc, 7, v135
    s_nop 1
    v_cndmask_b32 v27, v27, v138, vcc
    s_mov_b32 s33, 400000
    v_and_b32 v138, 63, v0
    v_lshrrev_b32 v139, 4, v138
    v_lshlrev_b32 v139, 1, v139
    v_and_b32 v140, 15, v138
    v_xor_b32 v140, v140, v139
    v_lshlrev_b32 v140, 4, v140
    v_bfe_u32 v139, v138, 5, 1
    v_lshlrev_b32 v139, 6, v139
    v_bfe_u32 v137, v138, 4, 1
    v_lshl_add_u32 v139, v137, 4, v139
    v_lshl_add_u32 v134, v139, 13, v140
    v_bfe_u32 v139, v138, 5, 1
    v_lshlrev_b32 v139, 4, v139
    v_add_u32 v139, v139, v137
    v_lshl_add_u32 v135, v139, 10, v140
    v_xor_b32 v141, 0x80, v134
    v_xor_b32 v142, 0x80, v135
    v_lshrrev_b32 v139, 4, v138
    v_lshlrev_b32 v139, 3, v139
    v_bfe_u32 v140, v138, 2, 2
    v_add_u32 v139, v139, v140
    v_lshlrev_b32 v136, 8, v139
    v_lshlrev_b32 v140, 1, v140
    v_bfe_u32 v139, v138, 4, 1
    v_lshl_add_u32 v140, v139, 3, v140
    v_bfe_u32 v139, v138, 1, 1
    v_xor_b32 v140, v140, v139
    v_lshl_add_u32 v136, v140, 4, v136
    v_and_b32 v139, 1, v138
    v_lshl_add_u32 v136, v139, 3, v136
    s_and_b32 s34, s25, 1
    s_lshl_b32 s34, s34, 15
    s_lshr_b32 s35, s25, 1
    s_lshl_b32 s35, s35, 16
    s_add_u32 s34, s34, s35
    s_lshl_b32 s35, s24, 8
    s_add_u32 s36, s34, s35
    s_lshl_b32 s34, s24, 17
    s_lshl_b32 s35, s25, 8
    s_add_u32 s37, s34, s35
    s_lshl_b32 s56, s25, 14
    s_add_u32 s56, s56, 16384
    s_lshl_b32 s57, s25, 12
    s_add_u32 s57, s57, 16384
    s_mov_b32 s20, s64
    s_mov_b32 s21, s65
    s_mov_b32 s22, 0x400000
    s_mov_b32 s23, 0x20000
    s_add_u32 s34, s36, 1048576
    s_add_u32 m0, s57, 0
    s_nop 0
    buffer_load_dwordx4 v134, s[20:23], s34 offen lds
    s_add_u32 s34, s36, 1056768
    s_add_u32 m0, s57, 1024
    s_nop 0
    buffer_load_dwordx4 v134, s[20:23], s34 offen lds
    s_add_u32 s34, s36, 1064960
    s_add_u32 m0, s57, 2048
    s_nop 0
    buffer_load_dwordx4 v141, s[20:23], s34 offen lds
    s_add_u32 s34, s36, 1073152
    s_add_u32 m0, s57, 3072
    s_nop 0
    buffer_load_dwordx4 v141, s[20:23], s34 offen lds
    s_mov_b32 s20, s70
    s_mov_b32 s21, s71
    s_mov_b32 s22, 0x400000
    s_mov_b32 s23, 0x20000
    s_add_u32 s34, s37, 0
    s_add_u32 m0, s56, 16384
    s_nop 0
    buffer_load_dwordx4 v135, s[20:23], s34 offen lds
    s_add_u32 s34, s37, 2048
    s_add_u32 m0, s56, 17408
    s_nop 0
    buffer_load_dwordx4 v135, s[20:23], s34 offen lds
    s_add_u32 s34, s37, 4096
    s_add_u32 m0, s56, 18432
    s_nop 0
    buffer_load_dwordx4 v142, s[20:23], s34 offen lds
    s_add_u32 s34, s37, 6144
    s_add_u32 m0, s56, 19456
    s_nop 0
    buffer_load_dwordx4 v142, s[20:23], s34 offen lds
    s_add_u32 s34, s37, 8192
    s_add_u32 m0, s56, 20480
    s_nop 0
    buffer_load_dwordx4 v135, s[20:23], s34 offen lds
    s_add_u32 s34, s37, 10240
    s_add_u32 m0, s56, 21504
    s_nop 0
    buffer_load_dwordx4 v135, s[20:23], s34 offen lds
    s_add_u32 s34, s37, 12288
    s_add_u32 m0, s56, 22528
    s_nop 0
    buffer_load_dwordx4 v142, s[20:23], s34 offen lds
    s_add_u32 s34, s37, 14336
    s_add_u32 m0, s56, 23552
    s_nop 0
    buffer_load_dwordx4 v142, s[20:23], s34 offen lds
    s_add_u32 s34, s37, 32768
    s_add_u32 m0, s56, 24576
    s_nop 0
    buffer_load_dwordx4 v135, s[20:23], s34 offen lds
    s_add_u32 s34, s37, 34816
    s_add_u32 m0, s56, 25600
    s_nop 0
    buffer_load_dwordx4 v135, s[20:23], s34 offen lds
    s_add_u32 s34, s37, 36864
    s_add_u32 m0, s56, 26624
    s_nop 0
    buffer_load_dwordx4 v142, s[20:23], s34 offen lds
    s_add_u32 s34, s37, 38912
    s_add_u32 m0, s56, 27648
    s_nop 0
    buffer_load_dwordx4 v142, s[20:23], s34 offen lds
    s_add_u32 s34, s37, 40960
    s_add_u32 m0, s56, 28672
    s_nop 0
    buffer_load_dwordx4 v135, s[20:23], s34 offen lds
    s_add_u32 s34, s37, 43008
    s_add_u32 m0, s56, 29696
    s_nop 0
    buffer_load_dwordx4 v135, s[20:23], s34 offen lds
    s_add_u32 s34, s37, 45056
    s_add_u32 m0, s56, 30720
    s_nop 0
    buffer_load_dwordx4 v142, s[20:23], s34 offen lds
    s_add_u32 s34, s37, 47104
    s_add_u32 m0, s56, 31744
    s_nop 0
    buffer_load_dwordx4 v142, s[20:23], s34 offen lds
    s_add_u32 s34, s37, 65536
    s_add_u32 m0, s56, 81920
    s_nop 0
    buffer_load_dwordx4 v135, s[20:23], s34 offen lds
    s_add_u32 s34, s37, 67584
    s_add_u32 m0, s56, 82944
    s_nop 0
    buffer_load_dwordx4 v135, s[20:23], s34 offen lds
    s_add_u32 s34, s37, 69632
    s_add_u32 m0, s56, 83968
    s_nop 0
    buffer_load_dwordx4 v142, s[20:23], s34 offen lds
    s_add_u32 s34, s37, 71680
    s_add_u32 m0, s56, 84992
    s_nop 0
    buffer_load_dwordx4 v142, s[20:23], s34 offen lds
    s_add_u32 s34, s37, 73728
    s_add_u32 m0, s56, 86016
    s_nop 0
    buffer_load_dwordx4 v135, s[20:23], s34 offen lds
    s_add_u32 s34, s37, 75776
    s_add_u32 m0, s56, 87040
    s_nop 0
    buffer_load_dwordx4 v135, s[20:23], s34 offen lds
    s_add_u32 s34, s37, 77824
    s_add_u32 m0, s56, 88064
    s_nop 0
    buffer_load_dwordx4 v142, s[20:23], s34 offen lds
    s_add_u32 s34, s37, 79872
    s_add_u32 m0, s56, 89088
    s_nop 0
    buffer_load_dwordx4 v142, s[20:23], s34 offen lds
    s_add_u32 s34, s37, 98304
    s_add_u32 m0, s56, 90112
    s_nop 0
    buffer_load_dwordx4 v135, s[20:23], s34 offen lds
    s_add_u32 s34, s37, 100352
    s_add_u32 m0, s56, 91136
    s_nop 0
    buffer_load_dwordx4 v135, s[20:23], s34 offen lds
    s_add_u32 s34, s37, 102400
    s_add_u32 m0, s56, 92160
    s_nop 0
    buffer_load_dwordx4 v142, s[20:23], s34 offen lds
    s_add_u32 s34, s37, 104448
    s_add_u32 m0, s56, 93184
    s_nop 0
    buffer_load_dwordx4 v142, s[20:23], s34 offen lds
    s_add_u32 s34, s37, 106496
    s_add_u32 m0, s56, 94208
    s_nop 0
    buffer_load_dwordx4 v135, s[20:23], s34 offen lds
    s_add_u32 s34, s37, 108544
    s_add_u32 m0, s56, 95232
    s_nop 0
    buffer_load_dwordx4 v135, s[20:23], s34 offen lds
    s_add_u32 s34, s37, 110592
    s_add_u32 m0, s56, 96256
    s_nop 0
    buffer_load_dwordx4 v142, s[20:23], s34 offen lds
    s_add_u32 s34, s37, 112640
    s_add_u32 m0, s56, 97280
    s_nop 0
    buffer_load_dwordx4 v142, s[20:23], s34 offen lds
    v_mov_b32 v94, -1
    v_mov_b32 v95, -1
    v_mov_b32 v96, -1
    v_mov_b32 v97, -1
    s_add_u32 s34, s59, 0
    buffer_store_dwordx4 v[94:97], v2, s[4:7], s34 offen sc1
    s_add_u32 s34, s59, 1024
    buffer_store_dwordx4 v[94:97], v2, s[4:7], s34 offen sc1
    s_add_u32 s34, s59, 262144
    buffer_store_dwordx4 v[94:97], v2, s[4:7], s34 offen sc1
    s_add_u32 s34, s59, 263168
    buffer_store_dwordx4 v[94:97], v2, s[4:7], s34 offen sc1
    s_add_u32 s34, s59, 524288
    buffer_store_dwordx4 v[94:97], v2, s[4:7], s34 offen sc1
    s_add_u32 s34, s59, 525312
    buffer_store_dwordx4 v[94:97], v2, s[4:7], s34 offen sc1
    s_lshl_b32 s34, s24, 8
    buffer_store_dword v94, v13, s[8:11], s34 offen sc1
    s_add_u32 s34, s34, 8192
    buffer_store_dword v94, v13, s[8:11], s34 offen sc1
    s_add_u32 s34, s34, 8192
    buffer_store_dword v94, v13, s[8:11], s34 offen sc1
    s_add_u32 s34, s34, 8192
    s_waitcnt vmcnt(25)
    v_xor_b32 v137, 0, v136
    v_add_u32 v137, s56, v137
    v_add_u32 v137, 16384, v137
    ds_read_b64_tr_b16 v[30:31], v137 offset:0
    ds_read_b64_tr_b16 v[32:33], v137 offset:1024
    ds_read_b64_tr_b16 v[34:35], v137 offset:8192
    ds_read_b64_tr_b16 v[36:37], v137 offset:9216
    v_xor_b32 v137, 32, v136
    v_add_u32 v137, s56, v137
    v_add_u32 v137, 16384, v137
    ds_read_b64_tr_b16 v[38:39], v137 offset:0
    ds_read_b64_tr_b16 v[40:41], v137 offset:1024
    ds_read_b64_tr_b16 v[42:43], v137 offset:8192
    ds_read_b64_tr_b16 v[44:45], v137 offset:9216
    s_waitcnt lgkmcnt(0)
    v_xor_b32 v137, 64, v136
    v_add_u32 v137, s56, v137
    v_add_u32 v137, 16384, v137
    ds_read_b64_tr_b16 v[176:177], v137 offset:0
    ds_read_b64_tr_b16 v[178:179], v137 offset:1024
    ds_read_b64_tr_b16 v[180:181], v137 offset:8192
    ds_read_b64_tr_b16 v[182:183], v137 offset:9216
    v_xor_b32 v137, 96, v136
    v_add_u32 v137, s56, v137
    v_add_u32 v137, 16384, v137
    ds_read_b64_tr_b16 v[184:185], v137 offset:0
    ds_read_b64_tr_b16 v[186:187], v137 offset:1024
    ds_read_b64_tr_b16 v[188:189], v137 offset:8192
    ds_read_b64_tr_b16 v[190:191], v137 offset:9216
    s_waitcnt lgkmcnt(0)
    v_xor_b32 v137, 128, v136
    v_add_u32 v137, s56, v137
    v_add_u32 v137, 16384, v137
    ds_read_b64_tr_b16 v[208:209], v137 offset:0
    ds_read_b64_tr_b16 v[210:211], v137 offset:1024
    ds_read_b64_tr_b16 v[212:213], v137 offset:8192
    ds_read_b64_tr_b16 v[214:215], v137 offset:9216
    v_xor_b32 v137, 160, v136
    v_add_u32 v137, s56, v137
    v_add_u32 v137, 16384, v137
    ds_read_b64_tr_b16 v[216:217], v137 offset:0
    ds_read_b64_tr_b16 v[218:219], v137 offset:1024
    ds_read_b64_tr_b16 v[220:221], v137 offset:8192
    ds_read_b64_tr_b16 v[222:223], v137 offset:9216
    s_waitcnt lgkmcnt(0)
    v_xor_b32 v137, 192, v136
    v_add_u32 v137, s56, v137
    v_add_u32 v137, 16384, v137
    ds_read_b64_tr_b16 v[240:241], v137 offset:0
    ds_read_b64_tr_b16 v[242:243], v137 offset:1024
    ds_read_b64_tr_b16 v[244:245], v137 offset:8192
    ds_read_b64_tr_b16 v[246:247], v137 offset:9216
    v_xor_b32 v137, 224, v136
    v_add_u32 v137, s56, v137
    v_add_u32 v137, 16384, v137
    ds_read_b64_tr_b16 v[248:249], v137 offset:0
    ds_read_b64_tr_b16 v[250:251], v137 offset:1024
    ds_read_b64_tr_b16 v[252:253], v137 offset:8192
    ds_read_b64_tr_b16 v[254:255], v137 offset:9216
    s_waitcnt lgkmcnt(0)
    s_barrier
    s_mov_b32 s20, s64
    s_mov_b32 s21, s65
    s_mov_b32 s22, 0x400000
    s_mov_b32 s23, 0x20000
    s_add_u32 s34, s36, 1310720
    s_add_u32 m0, s57, 16384
    s_nop 0
    buffer_load_dwordx4 v134, s[20:23], s34 offen lds
    s_add_u32 s34, s36, 1318912
    s_add_u32 m0, s57, 17408
    s_nop 0
    buffer_load_dwordx4 v134, s[20:23], s34 offen lds
    s_add_u32 s34, s36, 1327104
    s_add_u32 m0, s57, 18432
    s_nop 0
    buffer_load_dwordx4 v141, s[20:23], s34 offen lds
    s_add_u32 s34, s36, 1335296
    s_add_u32 m0, s57, 19456
    s_nop 0
    buffer_load_dwordx4 v141, s[20:23], s34 offen lds
    s_add_u32 s34, s36, 2097152
    s_add_u32 m0, s57, 32768
    s_nop 0
    buffer_load_dwordx4 v134, s[20:23], s34 offen lds
    s_add_u32 s34, s36, 2105344
    s_add_u32 m0, s57, 33792
    s_nop 0
    buffer_load_dwordx4 v134, s[20:23], s34 offen lds
    s_add_u32 s34, s36, 2113536
    s_add_u32 m0, s57, 34816
    s_nop 0
    buffer_load_dwordx4 v141, s[20:23], s34 offen lds
    s_add_u32 s34, s36, 2121728
    s_add_u32 m0, s57, 35840
    s_nop 0
    buffer_load_dwordx4 v141, s[20:23], s34 offen lds
    s_add_u32 s34, s36, 2359296
    s_add_u32 m0, s57, 49152
    s_nop 0
    buffer_load_dwordx4 v134, s[20:23], s34 offen lds
    s_add_u32 s34, s36, 2367488
    s_add_u32 m0, s57, 50176
    s_nop 0
    buffer_load_dwordx4 v134, s[20:23], s34 offen lds
    s_add_u32 s34, s36, 2375680
    s_add_u32 m0, s57, 51200
    s_nop 0
    buffer_load_dwordx4 v141, s[20:23], s34 offen lds
    s_add_u32 s34, s36, 2383872
    s_add_u32 m0, s57, 52224
    s_nop 0
    buffer_load_dwordx4 v141, s[20:23], s34 offen lds
    s_add_u32 s34, s36, 3145728
    s_add_u32 m0, s57, 65536
    s_nop 0
    buffer_load_dwordx4 v134, s[20:23], s34 offen lds
    s_add_u32 s34, s36, 3153920
    s_add_u32 m0, s57, 66560
    s_nop 0
    buffer_load_dwordx4 v134, s[20:23], s34 offen lds
    s_add_u32 s34, s36, 3162112
    s_add_u32 m0, s57, 67584
    s_nop 0
    buffer_load_dwordx4 v141, s[20:23], s34 offen lds
    s_add_u32 s34, s36, 3170304
    s_add_u32 m0, s57, 68608
    s_nop 0
    buffer_load_dwordx4 v141, s[20:23], s34 offen lds
    s_waitcnt vmcnt(25)
    v_xor_b32 v137, 0, v136
    v_add_u32 v137, s56, v137
    v_add_u32 v137, 81920, v137
    ds_read_b64_tr_b16 v[46:47], v137 offset:0
    ds_read_b64_tr_b16 v[48:49], v137 offset:1024
    ds_read_b64_tr_b16 v[50:51], v137 offset:8192
    ds_read_b64_tr_b16 v[52:53], v137 offset:9216
    v_xor_b32 v137, 32, v136
    v_add_u32 v137, s56, v137
    v_add_u32 v137, 81920, v137
    ds_read_b64_tr_b16 v[54:55], v137 offset:0
    ds_read_b64_tr_b16 v[56:57], v137 offset:1024
    ds_read_b64_tr_b16 v[58:59], v137 offset:8192
    ds_read_b64_tr_b16 v[60:61], v137 offset:9216
    s_waitcnt lgkmcnt(0)
    v_xor_b32 v137, 64, v136
    v_add_u32 v137, s56, v137
    v_add_u32 v137, 81920, v137
    ds_read_b64_tr_b16 v[192:193], v137 offset:0
    ds_read_b64_tr_b16 v[194:195], v137 offset:1024
    ds_read_b64_tr_b16 v[196:197], v137 offset:8192
    ds_read_b64_tr_b16 v[198:199], v137 offset:9216
    v_xor_b32 v137, 96, v136
    v_add_u32 v137, s56, v137
    v_add_u32 v137, 81920, v137
    ds_read_b64_tr_b16 v[200:201], v137 offset:0
    ds_read_b64_tr_b16 v[202:203], v137 offset:1024
    ds_read_b64_tr_b16 v[204:205], v137 offset:8192
    ds_read_b64_tr_b16 v[206:207], v137 offset:9216
    s_waitcnt lgkmcnt(0)
    v_xor_b32 v137, 128, v136
    v_add_u32 v137, s56, v137
    v_add_u32 v137, 81920, v137
    ds_read_b64_tr_b16 v[224:225], v137 offset:0
    ds_read_b64_tr_b16 v[226:227], v137 offset:1024
    ds_read_b64_tr_b16 v[228:229], v137 offset:8192
    ds_read_b64_tr_b16 v[230:231], v137 offset:9216
    v_xor_b32 v137, 160, v136
    v_add_u32 v137, s56, v137
    v_add_u32 v137, 81920, v137
    ds_read_b64_tr_b16 v[232:233], v137 offset:0
    ds_read_b64_tr_b16 v[234:235], v137 offset:1024
    ds_read_b64_tr_b16 v[236:237], v137 offset:8192
    ds_read_b64_tr_b16 v[238:239], v137 offset:9216
    s_waitcnt lgkmcnt(0)
    v_xor_b32 v137, 192, v136
    v_add_u32 v137, s56, v137
    v_add_u32 v137, 81920, v137
    ds_read_b64_tr_b16 v[78:79], v137 offset:0
    ds_read_b64_tr_b16 v[80:81], v137 offset:1024
    ds_read_b64_tr_b16 v[82:83], v137 offset:8192
    ds_read_b64_tr_b16 v[84:85], v137 offset:9216
    v_xor_b32 v137, 224, v136
    v_add_u32 v137, s56, v137
    v_add_u32 v137, 81920, v137
    ds_read_b64_tr_b16 v[86:87], v137 offset:0
    ds_read_b64_tr_b16 v[88:89], v137 offset:1024
    ds_read_b64_tr_b16 v[90:91], v137 offset:8192
    ds_read_b64_tr_b16 v[92:93], v137 offset:9216
    s_waitcnt lgkmcnt(0)
    s_barrier
    s_add_u32 s34, s36, 3407872
    s_add_u32 m0, s57, 81920
    s_nop 0
    buffer_load_dwordx4 v134, s[20:23], s34 offen lds
    s_add_u32 s34, s36, 3416064
    s_add_u32 m0, s57, 82944
    s_nop 0
    buffer_load_dwordx4 v134, s[20:23], s34 offen lds
    s_add_u32 s34, s36, 3424256
    s_add_u32 m0, s57, 83968
    s_nop 0
    buffer_load_dwordx4 v141, s[20:23], s34 offen lds
    s_add_u32 s34, s36, 3432448
    s_add_u32 m0, s57, 84992
    s_nop 0
    buffer_load_dwordx4 v141, s[20:23], s34 offen lds
    s_mov_b32 s20, s66
    s_mov_b32 s21, s67
    s_mov_b32 s22, 0x400000
    s_mov_b32 s23, 0x20000
    s_add_u32 s34, s36, 0
    s_add_u32 m0, s57, 98304
    s_nop 0
    buffer_load_dwordx4 v134, s[20:23], s34 offen lds
    s_add_u32 s34, s36, 8192
    s_add_u32 m0, s57, 99328
    s_nop 0
    buffer_load_dwordx4 v134, s[20:23], s34 offen lds
    s_add_u32 s34, s36, 16384
    s_add_u32 m0, s57, 100352
    s_nop 0
    buffer_load_dwordx4 v141, s[20:23], s34 offen lds
    s_add_u32 s34, s36, 24576
    s_add_u32 m0, s57, 101376
    s_nop 0
    buffer_load_dwordx4 v141, s[20:23], s34 offen lds
    s_add_u32 s34, s36, 262144
    s_add_u32 m0, s57, 114688
    s_nop 0
    buffer_load_dwordx4 v134, s[20:23], s34 offen lds
    s_add_u32 s34, s36, 270336
    s_add_u32 m0, s57, 115712
    s_nop 0
    buffer_load_dwordx4 v134, s[20:23], s34 offen lds
    s_add_u32 s34, s36, 278528
    s_add_u32 m0, s57, 116736
    s_nop 0
    buffer_load_dwordx4 v141, s[20:23], s34 offen lds
    s_add_u32 s34, s36, 286720
    s_add_u32 m0, s57, 117760
    s_nop 0
    buffer_load_dwordx4 v141, s[20:23], s34 offen lds
    s_add_u32 s34, s36, 1048576
    s_add_u32 m0, s57, 131072
    s_nop 0
    buffer_load_dwordx4 v134, s[20:23], s34 offen lds
    s_add_u32 s34, s36, 1056768
    s_add_u32 m0, s57, 132096
    s_nop 0
    buffer_load_dwordx4 v134, s[20:23], s34 offen lds
    s_add_u32 s34, s36, 1064960
    s_add_u32 m0, s57, 133120
    s_nop 0
    buffer_load_dwordx4 v141, s[20:23], s34 offen lds
    s_add_u32 s34, s36, 1073152
    s_add_u32 m0, s57, 134144
    s_nop 0
    buffer_load_dwordx4 v141, s[20:23], s34 offen lds
    s_barrier
    s_lshl_b32 s34, s25, 6
    s_add_u32 s34, s34, 0
    v_xor_b32 v137, s34, v136
    v_add_u32 v137, 16384, v137
    ds_read_b64_tr_b16 a[0:1], v137 offset:0
    ds_read_b64_tr_b16 a[2:3], v137 offset:1024
    ds_read_b64_tr_b16 a[4:5], v137 offset:8192
    ds_read_b64_tr_b16 a[6:7], v137 offset:9216
    s_lshl_b32 s34, s25, 6
    s_add_u32 s34, s34, 32
    v_xor_b32 v137, s34, v136
    v_add_u32 v137, 16384, v137
    ds_read_b64_tr_b16 a[8:9], v137 offset:0
    ds_read_b64_tr_b16 a[10:11], v137 offset:1024
    ds_read_b64_tr_b16 a[12:13], v137 offset:8192
    ds_read_b64_tr_b16 a[14:15], v137 offset:9216
    s_waitcnt lgkmcnt(0)
    s_waitcnt vmcnt(28)
    s_barrier
    s_add_u32 s34, s36, 1310720
    s_add_u32 m0, s57, 0
    s_nop 0
    buffer_load_dwordx4 v134, s[20:23], s34 offen lds
    s_add_u32 s34, s36, 1318912
    s_add_u32 m0, s57, 1024
    s_nop 0
    buffer_load_dwordx4 v134, s[20:23], s34 offen lds
    s_add_u32 s34, s36, 1327104
    s_add_u32 m0, s57, 2048
    s_nop 0
    buffer_load_dwordx4 v141, s[20:23], s34 offen lds
    s_add_u32 s34, s36, 1335296
    s_add_u32 m0, s57, 3072
    s_nop 0
    buffer_load_dwordx4 v141, s[20:23], s34 offen lds
    s_lshl_b32 s34, s25, 6
    s_add_u32 s34, s34, 0
    v_xor_b32 v137, s34, v136
    v_add_u32 v137, 32768, v137
    ds_read_b64_tr_b16 a[16:17], v137 offset:0
    ds_read_b64_tr_b16 a[18:19], v137 offset:1024
    ds_read_b64_tr_b16 a[20:21], v137 offset:8192
    ds_read_b64_tr_b16 a[22:23], v137 offset:9216
    s_lshl_b32 s34, s25, 6
    s_add_u32 s34, s34, 32
    v_xor_b32 v137, s34, v136
    v_add_u32 v137, 32768, v137
    ds_read_b64_tr_b16 a[24:25], v137 offset:0
    ds_read_b64_tr_b16 a[26:27], v137 offset:1024
    ds_read_b64_tr_b16 a[28:29], v137 offset:8192
    ds_read_b64_tr_b16 a[30:31], v137 offset:9216
    s_waitcnt lgkmcnt(0)
    s_waitcnt vmcnt(28)
    s_barrier
    s_add_u32 s34, s36, 2097152
    s_add_u32 m0, s57, 16384
    s_nop 0
    buffer_load_dwordx4 v134, s[20:23], s34 offen lds
    s_add_u32 s34, s36, 2105344
    s_add_u32 m0, s57, 17408
    s_nop 0
    buffer_load_dwordx4 v134, s[20:23], s34 offen lds
    s_add_u32 s34, s36, 2113536
    s_add_u32 m0, s57, 18432
    s_nop 0
    buffer_load_dwordx4 v141, s[20:23], s34 offen lds
    s_add_u32 s34, s36, 2121728
    s_add_u32 m0, s57, 19456
    s_nop 0
    buffer_load_dwordx4 v141, s[20:23], s34 offen lds
    s_lshl_b32 s34, s25, 6
    s_add_u32 s34, s34, 0
    v_xor_b32 v137, s34, v136
    v_add_u32 v137, 49152, v137
    ds_read_b64_tr_b16 a[32:33], v137 offset:0
    ds_read_b64_tr_b16 a[34:35], v137 offset:1024
    ds_read_b64_tr_b16 a[36:37], v137 offset:8192
    ds_read_b64_tr_b16 a[38:39], v137 offset:9216
    s_lshl_b32 s34, s25, 6
    s_add_u32 s34, s34, 32
    v_xor_b32 v137, s34, v136
    v_add_u32 v137, 49152, v137
    ds_read_b64_tr_b16 a[40:41], v137 offset:0
    ds_read_b64_tr_b16 a[42:43], v137 offset:1024
    ds_read_b64_tr_b16 a[44:45], v137 offset:8192
    ds_read_b64_tr_b16 a[46:47], v137 offset:9216
    s_waitcnt lgkmcnt(0)
    s_waitcnt vmcnt(28)
    s_barrier
    s_add_u32 s34, s36, 2359296
    s_add_u32 m0, s57, 32768
    s_nop 0
    buffer_load_dwordx4 v134, s[20:23], s34 offen lds
    s_add_u32 s34, s36, 2367488
    s_add_u32 m0, s57, 33792
    s_nop 0
    buffer_load_dwordx4 v134, s[20:23], s34 offen lds
    s_add_u32 s34, s36, 2375680
    s_add_u32 m0, s57, 34816
    s_nop 0
    buffer_load_dwordx4 v141, s[20:23], s34 offen lds
    s_add_u32 s34, s36, 2383872
    s_add_u32 m0, s57, 35840
    s_nop 0
    buffer_load_dwordx4 v141, s[20:23], s34 offen lds
    s_lshl_b32 s34, s25, 6
    s_add_u32 s34, s34, 0
    v_xor_b32 v137, s34, v136
    v_add_u32 v137, 65536, v137
    ds_read_b64_tr_b16 a[48:49], v137 offset:0
    ds_read_b64_tr_b16 a[50:51], v137 offset:1024
    ds_read_b64_tr_b16 a[52:53], v137 offset:8192
    ds_read_b64_tr_b16 a[54:55], v137 offset:9216
    s_lshl_b32 s34, s25, 6
    s_add_u32 s34, s34, 32
    v_xor_b32 v137, s34, v136
    v_add_u32 v137, 65536, v137
    ds_read_b64_tr_b16 a[56:57], v137 offset:0
    ds_read_b64_tr_b16 a[58:59], v137 offset:1024
    ds_read_b64_tr_b16 a[60:61], v137 offset:8192
    ds_read_b64_tr_b16 a[62:63], v137 offset:9216
    s_waitcnt lgkmcnt(0)
    s_waitcnt vmcnt(28)
    s_barrier
    s_mov_b32 s20, s68
    s_mov_b32 s21, s69
    s_mov_b32 s22, 0x400000
    s_mov_b32 s23, 0x20000
    s_add_u32 s34, s36, 0
    s_add_u32 m0, s57, 49152
    s_nop 0
    buffer_load_dwordx4 v134, s[20:23], s34 offen lds
    s_add_u32 s34, s36, 8192
    s_add_u32 m0, s57, 50176
    s_nop 0
    buffer_load_dwordx4 v134, s[20:23], s34 offen lds
    s_add_u32 s34, s36, 16384
    s_add_u32 m0, s57, 51200
    s_nop 0
    buffer_load_dwordx4 v141, s[20:23], s34 offen lds
    s_add_u32 s34, s36, 24576
    s_add_u32 m0, s57, 52224
    s_nop 0
    buffer_load_dwordx4 v141, s[20:23], s34 offen lds
    s_lshl_b32 s34, s25, 6
    s_add_u32 s34, s34, 0
    v_xor_b32 v137, s34, v136
    v_add_u32 v137, 81920, v137
    ds_read_b64_tr_b16 a[64:65], v137 offset:0
    ds_read_b64_tr_b16 a[66:67], v137 offset:1024
    ds_read_b64_tr_b16 a[68:69], v137 offset:8192
    ds_read_b64_tr_b16 a[70:71], v137 offset:9216
    s_lshl_b32 s34, s25, 6
    s_add_u32 s34, s34, 32
    v_xor_b32 v137, s34, v136
    v_add_u32 v137, 81920, v137
    ds_read_b64_tr_b16 a[72:73], v137 offset:0
    ds_read_b64_tr_b16 a[74:75], v137 offset:1024
    ds_read_b64_tr_b16 a[76:77], v137 offset:8192
    ds_read_b64_tr_b16 a[78:79], v137 offset:9216
    s_waitcnt lgkmcnt(0)
    s_waitcnt vmcnt(28)
    s_barrier
    s_add_u32 s34, s36, 262144
    s_add_u32 m0, s57, 65536
    s_nop 0
    buffer_load_dwordx4 v134, s[20:23], s34 offen lds
    s_add_u32 s34, s36, 270336
    s_add_u32 m0, s57, 66560
    s_nop 0
    buffer_load_dwordx4 v134, s[20:23], s34 offen lds
    s_add_u32 s34, s36, 278528
    s_add_u32 m0, s57, 67584
    s_nop 0
    buffer_load_dwordx4 v141, s[20:23], s34 offen lds
    s_add_u32 s34, s36, 286720
    s_add_u32 m0, s57, 68608
    s_nop 0
    buffer_load_dwordx4 v141, s[20:23], s34 offen lds
    s_lshl_b32 s34, s25, 6
    s_add_u32 s34, s34, 0
    v_xor_b32 v137, s34, v136
    v_add_u32 v137, 98304, v137
    ds_read_b64_tr_b16 a[80:81], v137 offset:0
    ds_read_b64_tr_b16 a[82:83], v137 offset:1024
    ds_read_b64_tr_b16 a[84:85], v137 offset:8192
    ds_read_b64_tr_b16 a[86:87], v137 offset:9216
    s_lshl_b32 s34, s25, 6
    s_add_u32 s34, s34, 32
    v_xor_b32 v137, s34, v136
    v_add_u32 v137, 98304, v137
    ds_read_b64_tr_b16 a[88:89], v137 offset:0
    ds_read_b64_tr_b16 a[90:91], v137 offset:1024
    ds_read_b64_tr_b16 a[92:93], v137 offset:8192
    ds_read_b64_tr_b16 a[94:95], v137 offset:9216
    s_waitcnt lgkmcnt(0)
    s_waitcnt vmcnt(28)
    s_barrier
    s_add_u32 s34, s36, 1048576
    s_add_u32 m0, s57, 81920
    s_nop 0
    buffer_load_dwordx4 v134, s[20:23], s34 offen lds
    s_add_u32 s34, s36, 1056768
    s_add_u32 m0, s57, 82944
    s_nop 0
    buffer_load_dwordx4 v134, s[20:23], s34 offen lds
    s_add_u32 s34, s36, 1064960
    s_add_u32 m0, s57, 83968
    s_nop 0
    buffer_load_dwordx4 v141, s[20:23], s34 offen lds
    s_add_u32 s34, s36, 1073152
    s_add_u32 m0, s57, 84992
    s_nop 0
    buffer_load_dwordx4 v141, s[20:23], s34 offen lds
    s_lshl_b32 s34, s25, 6
    s_add_u32 s34, s34, 0
    v_xor_b32 v137, s34, v136
    v_add_u32 v137, 114688, v137
    ds_read_b64_tr_b16 a[96:97], v137 offset:0
    ds_read_b64_tr_b16 a[98:99], v137 offset:1024
    ds_read_b64_tr_b16 a[100:101], v137 offset:8192
    ds_read_b64_tr_b16 a[102:103], v137 offset:9216
    s_lshl_b32 s34, s25, 6
    s_add_u32 s34, s34, 32
    v_xor_b32 v137, s34, v136
    v_add_u32 v137, 114688, v137
    ds_read_b64_tr_b16 a[104:105], v137 offset:0
    ds_read_b64_tr_b16 a[106:107], v137 offset:1024
    ds_read_b64_tr_b16 a[108:109], v137 offset:8192
    ds_read_b64_tr_b16 a[110:111], v137 offset:9216
    s_waitcnt lgkmcnt(0)
    s_waitcnt vmcnt(28)
    s_barrier
    s_add_u32 s34, s36, 1310720
    s_add_u32 m0, s57, 98304
    s_nop 0
    buffer_load_dwordx4 v134, s[20:23], s34 offen lds
    s_add_u32 s34, s36, 1318912
    s_add_u32 m0, s57, 99328
    s_nop 0
    buffer_load_dwordx4 v134, s[20:23], s34 offen lds
    s_add_u32 s34, s36, 1327104
    s_add_u32 m0, s57, 100352
    s_nop 0
    buffer_load_dwordx4 v141, s[20:23], s34 offen lds
    s_add_u32 s34, s36, 1335296
    s_add_u32 m0, s57, 101376
    s_nop 0
    buffer_load_dwordx4 v141, s[20:23], s34 offen lds
    s_lshl_b32 s34, s25, 6
    s_add_u32 s34, s34, 0
    v_xor_b32 v137, s34, v136
    v_add_u32 v137, 131072, v137
    ds_read_b64_tr_b16 a[112:113], v137 offset:0
    ds_read_b64_tr_b16 a[114:115], v137 offset:1024
    ds_read_b64_tr_b16 a[116:117], v137 offset:8192
    ds_read_b64_tr_b16 a[118:119], v137 offset:9216
    s_lshl_b32 s34, s25, 6
    s_add_u32 s34, s34, 32
    v_xor_b32 v137, s34, v136
    v_add_u32 v137, 131072, v137
    ds_read_b64_tr_b16 a[120:121], v137 offset:0
    ds_read_b64_tr_b16 a[122:123], v137 offset:1024
    ds_read_b64_tr_b16 a[124:125], v137 offset:8192
    ds_read_b64_tr_b16 a[126:127], v137 offset:9216
    s_waitcnt lgkmcnt(0)
    s_waitcnt vmcnt(28)
    s_barrier
    s_add_u32 s34, s36, 2097152
    s_add_u32 m0, s57, 114688
    s_nop 0
    buffer_load_dwordx4 v134, s[20:23], s34 offen lds
    s_add_u32 s34, s36, 2105344
    s_add_u32 m0, s57, 115712
    s_nop 0
    buffer_load_dwordx4 v134, s[20:23], s34 offen lds
    s_add_u32 s34, s36, 2113536
    s_add_u32 m0, s57, 116736
    s_nop 0
    buffer_load_dwordx4 v141, s[20:23], s34 offen lds
    s_add_u32 s34, s36, 2121728
    s_add_u32 m0, s57, 117760
    s_nop 0
    buffer_load_dwordx4 v141, s[20:23], s34 offen lds
    s_lshl_b32 s34, s25, 6
    s_add_u32 s34, s34, 0
    v_xor_b32 v137, s34, v136
    v_add_u32 v137, 147456, v137
    ds_read_b64_tr_b16 a[128:129], v137 offset:0
    ds_read_b64_tr_b16 a[130:131], v137 offset:1024
    ds_read_b64_tr_b16 a[132:133], v137 offset:8192
    ds_read_b64_tr_b16 a[134:135], v137 offset:9216
    s_lshl_b32 s34, s25, 6
    s_add_u32 s34, s34, 32
    v_xor_b32 v137, s34, v136
    v_add_u32 v137, 147456, v137
    ds_read_b64_tr_b16 a[136:137], v137 offset:0
    ds_read_b64_tr_b16 a[138:139], v137 offset:1024
    ds_read_b64_tr_b16 a[140:141], v137 offset:8192
    ds_read_b64_tr_b16 a[142:143], v137 offset:9216
    s_waitcnt lgkmcnt(0)
    s_waitcnt vmcnt(28)
    s_barrier
    s_add_u32 s34, s36, 2359296
    s_add_u32 m0, s57, 131072
    s_nop 0
    buffer_load_dwordx4 v134, s[20:23], s34 offen lds
    s_add_u32 s34, s36, 2367488
    s_add_u32 m0, s57, 132096
    s_nop 0
    buffer_load_dwordx4 v134, s[20:23], s34 offen lds
    s_add_u32 s34, s36, 2375680
    s_add_u32 m0, s57, 133120
    s_nop 0
    buffer_load_dwordx4 v141, s[20:23], s34 offen lds
    s_add_u32 s34, s36, 2383872
    s_add_u32 m0, s57, 134144
    s_nop 0
    buffer_load_dwordx4 v141, s[20:23], s34 offen lds
    s_lshl_b32 s34, s25, 6
    s_add_u32 s34, s34, 0
    v_xor_b32 v137, s34, v136
    v_add_u32 v137, 16384, v137
    ds_read_b64_tr_b16 a[144:145], v137 offset:0
    ds_read_b64_tr_b16 a[146:147], v137 offset:1024
    ds_read_b64_tr_b16 a[148:149], v137 offset:8192
    ds_read_b64_tr_b16 a[150:151], v137 offset:9216
    s_lshl_b32 s34, s25, 6
    s_add_u32 s34, s34, 32
    v_xor_b32 v137, s34, v136
    v_add_u32 v137, 16384, v137
    ds_read_b64_tr_b16 a[152:153], v137 offset:0
    ds_read_b64_tr_b16 a[154:155], v137 offset:1024
    ds_read_b64_tr_b16 a[156:157], v137 offset:8192
    ds_read_b64_tr_b16 a[158:159], v137 offset:9216
    s_waitcnt lgkmcnt(0)
    s_waitcnt vmcnt(28)
    s_barrier
    s_mov_b32 s20, s64
    s_mov_b32 s21, s65
    s_mov_b32 s22, 0x400000
    s_mov_b32 s23, 0x20000
    s_add_u32 s34, s36, 0
    s_add_u32 m0, s57, 0
    s_nop 0
    buffer_load_dwordx4 v134, s[20:23], s34 offen lds
    s_add_u32 s34, s36, 8192
    s_add_u32 m0, s57, 1024
    s_nop 0
    buffer_load_dwordx4 v134, s[20:23], s34 offen lds
    s_add_u32 s34, s36, 16384
    s_add_u32 m0, s57, 2048
    s_nop 0
    buffer_load_dwordx4 v141, s[20:23], s34 offen lds
    s_add_u32 s34, s36, 24576
    s_add_u32 m0, s57, 3072
    s_nop 0
    buffer_load_dwordx4 v141, s[20:23], s34 offen lds
    s_lshl_b32 s34, s25, 6
    s_add_u32 s34, s34, 0
    v_xor_b32 v137, s34, v136
    v_add_u32 v137, 32768, v137
    ds_read_b64_tr_b16 a[160:161], v137 offset:0
    ds_read_b64_tr_b16 a[162:163], v137 offset:1024
    ds_read_b64_tr_b16 a[164:165], v137 offset:8192
    ds_read_b64_tr_b16 a[166:167], v137 offset:9216
    s_lshl_b32 s34, s25, 6
    s_add_u32 s34, s34, 32
    v_xor_b32 v137, s34, v136
    v_add_u32 v137, 32768, v137
    ds_read_b64_tr_b16 a[168:169], v137 offset:0
    ds_read_b64_tr_b16 a[170:171], v137 offset:1024
    ds_read_b64_tr_b16 a[172:173], v137 offset:8192
    ds_read_b64_tr_b16 a[174:175], v137 offset:9216
    s_waitcnt lgkmcnt(0)
    s_waitcnt vmcnt(28)
    s_barrier
    s_add_u32 s34, s36, 262144
    s_add_u32 m0, s57, 16384
    s_nop 0
    buffer_load_dwordx4 v134, s[20:23], s34 offen lds
    s_add_u32 s34, s36, 270336
    s_add_u32 m0, s57, 17408
    s_nop 0
    buffer_load_dwordx4 v134, s[20:23], s34 offen lds
    s_add_u32 s34, s36, 278528
    s_add_u32 m0, s57, 18432
    s_nop 0
    buffer_load_dwordx4 v141, s[20:23], s34 offen lds
    s_add_u32 s34, s36, 286720
    s_add_u32 m0, s57, 19456
    s_nop 0
    buffer_load_dwordx4 v141, s[20:23], s34 offen lds
    s_lshl_b32 s34, s25, 6
    s_add_u32 s34, s34, 0
    v_xor_b32 v137, s34, v136
    v_add_u32 v137, 49152, v137
    ds_read_b64_tr_b16 a[176:177], v137 offset:0
    ds_read_b64_tr_b16 a[178:179], v137 offset:1024
    ds_read_b64_tr_b16 a[180:181], v137 offset:8192
    ds_read_b64_tr_b16 a[182:183], v137 offset:9216
    s_lshl_b32 s34, s25, 6
    s_add_u32 s34, s34, 32
    v_xor_b32 v137, s34, v136
    v_add_u32 v137, 49152, v137
    ds_read_b64_tr_b16 a[184:185], v137 offset:0
    ds_read_b64_tr_b16 a[186:187], v137 offset:1024
    ds_read_b64_tr_b16 a[188:189], v137 offset:8192
    ds_read_b64_tr_b16 a[190:191], v137 offset:9216
    s_waitcnt lgkmcnt(0)
    s_waitcnt vmcnt(28)
    s_barrier
    s_mov_b32 s20, s66
    s_mov_b32 s21, s67
    s_mov_b32 s22, 0x400000
    s_mov_b32 s23, 0x20000
    s_add_u32 s34, s36, 3145728
    s_add_u32 m0, s57, 32768
    s_nop 0
    buffer_load_dwordx4 v134, s[20:23], s34 offen lds
    s_add_u32 s34, s36, 3153920
    s_add_u32 m0, s57, 33792
    s_nop 0
    buffer_load_dwordx4 v134, s[20:23], s34 offen lds
    s_add_u32 s34, s36, 3162112
    s_add_u32 m0, s57, 34816
    s_nop 0
    buffer_load_dwordx4 v141, s[20:23], s34 offen lds
    s_add_u32 s34, s36, 3170304
    s_add_u32 m0, s57, 35840
    s_nop 0
    buffer_load_dwordx4 v141, s[20:23], s34 offen lds
    s_lshl_b32 s34, s25, 6
    s_add_u32 s34, s34, 0
    v_xor_b32 v137, s34, v136
    v_add_u32 v137, 65536, v137
    ds_read_b64_tr_b16 a[192:193], v137 offset:0
    ds_read_b64_tr_b16 a[194:195], v137 offset:1024
    ds_read_b64_tr_b16 a[196:197], v137 offset:8192
    ds_read_b64_tr_b16 a[198:199], v137 offset:9216
    s_lshl_b32 s34, s25, 6
    s_add_u32 s34, s34, 32
    v_xor_b32 v137, s34, v136
    v_add_u32 v137, 65536, v137
    ds_read_b64_tr_b16 a[200:201], v137 offset:0
    ds_read_b64_tr_b16 a[202:203], v137 offset:1024
    ds_read_b64_tr_b16 a[204:205], v137 offset:8192
    ds_read_b64_tr_b16 a[206:207], v137 offset:9216
    s_waitcnt lgkmcnt(0)
    s_waitcnt vmcnt(28)
    s_barrier
    s_add_u32 s34, s36, 3407872
    s_add_u32 m0, s57, 49152
    s_nop 0
    buffer_load_dwordx4 v134, s[20:23], s34 offen lds
    s_add_u32 s34, s36, 3416064
    s_add_u32 m0, s57, 50176
    s_nop 0
    buffer_load_dwordx4 v134, s[20:23], s34 offen lds
    s_add_u32 s34, s36, 3424256
    s_add_u32 m0, s57, 51200
    s_nop 0
    buffer_load_dwordx4 v141, s[20:23], s34 offen lds
    s_add_u32 s34, s36, 3432448
    s_add_u32 m0, s57, 52224
    s_nop 0
    buffer_load_dwordx4 v141, s[20:23], s34 offen lds
    s_lshl_b32 s34, s25, 6
    s_add_u32 s34, s34, 0
    v_xor_b32 v137, s34, v136
    v_add_u32 v137, 81920, v137
    ds_read_b64_tr_b16 a[208:209], v137 offset:0
    ds_read_b64_tr_b16 a[210:211], v137 offset:1024
    ds_read_b64_tr_b16 a[212:213], v137 offset:8192
    ds_read_b64_tr_b16 a[214:215], v137 offset:9216
    s_lshl_b32 s34, s25, 6
    s_add_u32 s34, s34, 32
    v_xor_b32 v137, s34, v136
    v_add_u32 v137, 81920, v137
    ds_read_b64_tr_b16 a[216:217], v137 offset:0
    ds_read_b64_tr_b16 a[218:219], v137 offset:1024
    ds_read_b64_tr_b16 a[220:221], v137 offset:8192
    ds_read_b64_tr_b16 a[222:223], v137 offset:9216
    s_waitcnt lgkmcnt(0)
    s_waitcnt vmcnt(28)
    s_barrier
    s_mov_b32 s20, s68
    s_mov_b32 s21, s69
    s_mov_b32 s22, 0x400000
    s_mov_b32 s23, 0x20000
    s_add_u32 s34, s36, 3145728
    s_add_u32 m0, s57, 65536
    s_nop 0
    buffer_load_dwordx4 v134, s[20:23], s34 offen lds
    s_add_u32 s34, s36, 3153920
    s_add_u32 m0, s57, 66560
    s_nop 0
    buffer_load_dwordx4 v134, s[20:23], s34 offen lds
    s_add_u32 s34, s36, 3162112
    s_add_u32 m0, s57, 67584
    s_nop 0
    buffer_load_dwordx4 v141, s[20:23], s34 offen lds
    s_add_u32 s34, s36, 3170304
    s_add_u32 m0, s57, 68608
    s_nop 0
    buffer_load_dwordx4 v141, s[20:23], s34 offen lds
    s_lshl_b32 s34, s25, 6
    s_add_u32 s34, s34, 0
    v_xor_b32 v137, s34, v136
    v_add_u32 v137, 98304, v137
    ds_read_b64_tr_b16 a[224:225], v137 offset:0
    ds_read_b64_tr_b16 a[226:227], v137 offset:1024
    ds_read_b64_tr_b16 a[228:229], v137 offset:8192
    ds_read_b64_tr_b16 a[230:231], v137 offset:9216
    s_lshl_b32 s34, s25, 6
    s_add_u32 s34, s34, 32
    v_xor_b32 v137, s34, v136
    v_add_u32 v137, 98304, v137
    ds_read_b64_tr_b16 a[232:233], v137 offset:0
    ds_read_b64_tr_b16 a[234:235], v137 offset:1024
    ds_read_b64_tr_b16 a[236:237], v137 offset:8192
    ds_read_b64_tr_b16 a[238:239], v137 offset:9216
    s_waitcnt lgkmcnt(0)
    s_waitcnt vmcnt(28)
    s_barrier
    s_add_u32 s34, s36, 3407872
    s_add_u32 m0, s57, 81920
    s_nop 0
    buffer_load_dwordx4 v134, s[20:23], s34 offen lds
    s_add_u32 s34, s36, 3416064
    s_add_u32 m0, s57, 82944
    s_nop 0
    buffer_load_dwordx4 v134, s[20:23], s34 offen lds
    s_add_u32 s34, s36, 3424256
    s_add_u32 m0, s57, 83968
    s_nop 0
    buffer_load_dwordx4 v141, s[20:23], s34 offen lds
    s_add_u32 s34, s36, 3432448
    s_add_u32 m0, s57, 84992
    s_nop 0
    buffer_load_dwordx4 v141, s[20:23], s34 offen lds
    s_lshl_b32 s34, s25, 6
    s_add_u32 s34, s34, 0
    v_xor_b32 v137, s34, v136
    v_add_u32 v137, 114688, v137
    ds_read_b64_tr_b16 a[240:241], v137 offset:0
    ds_read_b64_tr_b16 a[242:243], v137 offset:1024
    ds_read_b64_tr_b16 a[244:245], v137 offset:8192
    ds_read_b64_tr_b16 a[246:247], v137 offset:9216
    s_lshl_b32 s34, s25, 6
    s_add_u32 s34, s34, 32
    v_xor_b32 v137, s34, v136
    v_add_u32 v137, 114688, v137
    ds_read_b64_tr_b16 a[248:249], v137 offset:0
    ds_read_b64_tr_b16 a[250:251], v137 offset:1024
    ds_read_b64_tr_b16 a[252:253], v137 offset:8192
    ds_read_b64_tr_b16 a[254:255], v137 offset:9216
    s_waitcnt lgkmcnt(0)
    s_waitcnt vmcnt(28)
    s_barrier
    s_lshl_b32 s34, s25, 6
    s_add_u32 s34, s34, 0
    v_xor_b32 v137, s34, v136
    v_add_u32 v137, 131072, v137
    ds_read_b64_tr_b16 v[144:145], v137 offset:0
    ds_read_b64_tr_b16 v[146:147], v137 offset:1024
    ds_read_b64_tr_b16 v[148:149], v137 offset:8192
    ds_read_b64_tr_b16 v[150:151], v137 offset:9216
    s_lshl_b32 s34, s25, 6
    s_add_u32 s34, s34, 32
    v_xor_b32 v137, s34, v136
    v_add_u32 v137, 131072, v137
    ds_read_b64_tr_b16 v[152:153], v137 offset:0
    ds_read_b64_tr_b16 v[154:155], v137 offset:1024
    ds_read_b64_tr_b16 v[156:157], v137 offset:8192
    ds_read_b64_tr_b16 v[158:159], v137 offset:9216
    s_waitcnt lgkmcnt(0)
    s_waitcnt vmcnt(24)
    s_barrier
    s_lshl_b32 s34, s25, 6
    s_add_u32 s34, s34, 0
    v_xor_b32 v137, s34, v136
    v_add_u32 v137, 147456, v137
    ds_read_b64_tr_b16 v[160:161], v137 offset:0
    ds_read_b64_tr_b16 v[162:163], v137 offset:1024
    ds_read_b64_tr_b16 v[164:165], v137 offset:8192
    ds_read_b64_tr_b16 v[166:167], v137 offset:9216
    s_lshl_b32 s34, s25, 6
    s_add_u32 s34, s34, 32
    v_xor_b32 v137, s34, v136
    v_add_u32 v137, 147456, v137
    ds_read_b64_tr_b16 v[168:169], v137 offset:0
    ds_read_b64_tr_b16 v[170:171], v137 offset:1024
    ds_read_b64_tr_b16 v[172:173], v137 offset:8192
    ds_read_b64_tr_b16 v[174:175], v137 offset:9216
    s_waitcnt lgkmcnt(0)
    s_waitcnt vmcnt(20)
    s_barrier
    s_lshl_b32 s34, s25, 6
    s_add_u32 s34, s34, 0
    v_xor_b32 v137, s34, v136
    v_add_u32 v137, 16384, v137
    ds_read_b64_tr_b16 v[62:63], v137 offset:0
    ds_read_b64_tr_b16 v[64:65], v137 offset:1024
    ds_read_b64_tr_b16 v[66:67], v137 offset:8192
    ds_read_b64_tr_b16 v[68:69], v137 offset:9216
    s_lshl_b32 s34, s25, 6
    s_add_u32 s34, s34, 32
    v_xor_b32 v137, s34, v136
    v_add_u32 v137, 16384, v137
    ds_read_b64_tr_b16 v[70:71], v137 offset:0
    ds_read_b64_tr_b16 v[72:73], v137 offset:1024
    ds_read_b64_tr_b16 v[74:75], v137 offset:8192
    ds_read_b64_tr_b16 v[76:77], v137 offset:9216
    s_waitcnt lgkmcnt(0)
    s_barrier
    ds_write_b128 v3, v[62:65] offset:0
    ds_write_b128 v3, v[66:69] offset:1024
    ds_write_b128 v3, v[70:73] offset:2048
    ds_write_b128 v3, v[74:77] offset:3072
    s_waitcnt lgkmcnt(0)
    s_waitcnt vmcnt(16)
    s_barrier
    s_lshl_b32 s34, s25, 6
    s_add_u32 s34, s34, 0
    v_xor_b32 v137, s34, v136
    v_add_u32 v137, 32768, v137
    ds_read_b64_tr_b16 v[62:63], v137 offset:0
    ds_read_b64_tr_b16 v[64:65], v137 offset:1024
    ds_read_b64_tr_b16 v[66:67], v137 offset:8192
    ds_read_b64_tr_b16 v[68:69], v137 offset:9216
    s_lshl_b32 s34, s25, 6
    s_add_u32 s34, s34, 32
    v_xor_b32 v137, s34, v136
    v_add_u32 v137, 32768, v137
    ds_read_b64_tr_b16 v[70:71], v137 offset:0
    ds_read_b64_tr_b16 v[72:73], v137 offset:1024
    ds_read_b64_tr_b16 v[74:75], v137 offset:8192
    ds_read_b64_tr_b16 v[76:77], v137 offset:9216
    s_waitcnt lgkmcnt(0)
    s_barrier
    ds_write_b128 v3, v[62:65] offset:16384
    ds_write_b128 v3, v[66:69] offset:17408
    ds_write_b128 v3, v[70:73] offset:18432
    ds_write_b128 v3, v[74:77] offset:19456
    s_waitcnt lgkmcnt(0)
    s_waitcnt vmcnt(12)
    s_barrier
    s_lshl_b32 s34, s25, 6
    s_add_u32 s34, s34, 0
    v_xor_b32 v137, s34, v136
    v_add_u32 v137, 49152, v137
    ds_read_b64_tr_b16 v[62:63], v137 offset:0
    ds_read_b64_tr_b16 v[64:65], v137 offset:1024
    ds_read_b64_tr_b16 v[66:67], v137 offset:8192
    ds_read_b64_tr_b16 v[68:69], v137 offset:9216
    s_lshl_b32 s34, s25, 6
    s_add_u32 s34, s34, 32
    v_xor_b32 v137, s34, v136
    v_add_u32 v137, 49152, v137
    ds_read_b64_tr_b16 v[70:71], v137 offset:0
    ds_read_b64_tr_b16 v[72:73], v137 offset:1024
    ds_read_b64_tr_b16 v[74:75], v137 offset:8192
    ds_read_b64_tr_b16 v[76:77], v137 offset:9216
    s_waitcnt lgkmcnt(0)
    s_barrier
    ds_write_b128 v3, v[62:65] offset:32768
    ds_write_b128 v3, v[66:69] offset:33792
    ds_write_b128 v3, v[70:73] offset:34816
    ds_write_b128 v3, v[74:77] offset:35840
    s_waitcnt lgkmcnt(0)
    s_waitcnt vmcnt(8)
    s_barrier
    s_lshl_b32 s34, s25, 6
    s_add_u32 s34, s34, 0
    v_xor_b32 v137, s34, v136
    v_add_u32 v137, 65536, v137
    ds_read_b64_tr_b16 v[62:63], v137 offset:0
    ds_read_b64_tr_b16 v[64:65], v137 offset:1024
    ds_read_b64_tr_b16 v[66:67], v137 offset:8192
    ds_read_b64_tr_b16 v[68:69], v137 offset:9216
    s_lshl_b32 s34, s25, 6
    s_add_u32 s34, s34, 32
    v_xor_b32 v137, s34, v136
    v_add_u32 v137, 65536, v137
    ds_read_b64_tr_b16 v[70:71], v137 offset:0
    ds_read_b64_tr_b16 v[72:73], v137 offset:1024
    ds_read_b64_tr_b16 v[74:75], v137 offset:8192
    ds_read_b64_tr_b16 v[76:77], v137 offset:9216
    s_waitcnt lgkmcnt(0)
    s_barrier
    ds_write_b128 v3, v[62:65] offset:49152
    ds_write_b128 v3, v[66:69] offset:50176
    ds_write_b128 v3, v[70:73] offset:51200
    ds_write_b128 v3, v[74:77] offset:52224
    s_waitcnt lgkmcnt(0)
    s_waitcnt vmcnt(4)
    s_barrier
    s_lshl_b32 s34, s25, 6
    s_add_u32 s34, s34, 0
    v_xor_b32 v137, s34, v136
    v_add_u32 v137, 81920, v137
    ds_read_b64_tr_b16 v[62:63], v137 offset:0
    ds_read_b64_tr_b16 v[64:65], v137 offset:1024
    ds_read_b64_tr_b16 v[66:67], v137 offset:8192
    ds_read_b64_tr_b16 v[68:69], v137 offset:9216
    s_lshl_b32 s34, s25, 6
    s_add_u32 s34, s34, 32
    v_xor_b32 v137, s34, v136
    v_add_u32 v137, 81920, v137
    ds_read_b64_tr_b16 v[70:71], v137 offset:0
    ds_read_b64_tr_b16 v[72:73], v137 offset:1024
    ds_read_b64_tr_b16 v[74:75], v137 offset:8192
    ds_read_b64_tr_b16 v[76:77], v137 offset:9216
    s_waitcnt lgkmcnt(0)
    s_barrier
    ds_write_b128 v7, v[62:65] offset:0
    ds_write_b128 v7, v[66:69] offset:1024
    ds_write_b128 v7, v[70:73] offset:2048
    ds_write_b128 v7, v[74:77] offset:3072
    s_waitcnt lgkmcnt(0)
    s_waitcnt vmcnt(0)
    s_barrier
    s_lshl_b32 s34, s25, 6
    s_add_u32 s34, s34, 0
    v_xor_b32 v137, s34, v136
    v_add_u32 v137, 98304, v137
    ds_read_b64_tr_b16 v[62:63], v137 offset:0
    ds_read_b64_tr_b16 v[64:65], v137 offset:1024
    ds_read_b64_tr_b16 v[66:67], v137 offset:8192
    ds_read_b64_tr_b16 v[68:69], v137 offset:9216
    s_lshl_b32 s34, s25, 6
    s_add_u32 s34, s34, 32
    v_xor_b32 v137, s34, v136
    v_add_u32 v137, 98304, v137
    ds_read_b64_tr_b16 v[70:71], v137 offset:0
    ds_read_b64_tr_b16 v[72:73], v137 offset:1024
    ds_read_b64_tr_b16 v[74:75], v137 offset:8192
    ds_read_b64_tr_b16 v[76:77], v137 offset:9216
    s_waitcnt lgkmcnt(0)
    s_barrier
    ds_write_b128 v7, v[62:65] offset:16384
    ds_write_b128 v7, v[66:69] offset:17408
    ds_write_b128 v7, v[70:73] offset:18432
    ds_write_b128 v7, v[74:77] offset:19456
    s_waitcnt lgkmcnt(0)
    s_barrier
    ds_write_b128 v7, v[30:33] offset:32768
    ds_write_b128 v7, v[34:37] offset:33792
    ds_write_b128 v7, v[38:41] offset:34816
    ds_write_b128 v7, v[42:45] offset:35840
    s_waitcnt lgkmcnt(0)
    ds_write_b128 v7, v[46:49] offset:49152
    ds_write_b128 v7, v[50:53] offset:50176
    ds_write_b128 v7, v[54:57] offset:51200
    ds_write_b128 v7, v[58:61] offset:52224
    s_waitcnt lgkmcnt(0)
    ds_write_b128 v8, v[78:81] offset:0
    ds_write_b128 v8, v[82:85] offset:1024
    ds_write_b128 v8, v[86:89] offset:2048
    ds_write_b128 v8, v[90:93] offset:3072
    s_waitcnt lgkmcnt(0)
    s_waitcnt vmcnt(0)
    s_cmp_eq_u32 s88, 1
    s_cbranch_scc1 L_c2done
    s_load_dwordx2 s[96:97], s[0:1], 96
    s_waitcnt lgkmcnt(0)
    s_mov_b32 s98, 256
    s_mov_b32 s99, 0x20000
    v_and_b32 v30, 63, v0
    v_lshlrev_b32 v31, 5, v30
    s_mov_b32 s95, 1000000
L2_cpoll:
    buffer_load_dword v32, v31, s[96:99], 0 offen sc1
    s_waitcnt vmcnt(0)
    v_mov_b32 v33, v32
    s_nop 1
    v_add_u32_dpp v33, v33, v33 row_shr:1 row_mask:0xf bank_mask:0xf bound_ctrl:0
    s_nop 1
    v_add_u32_dpp v33, v33, v33 row_shr:2 row_mask:0xf bank_mask:0xf bound_ctrl:0
    s_nop 1
    v_add_u32_dpp v33, v33, v33 row_shr:4 row_mask:0xf bank_mask:0xf bound_ctrl:0
    s_nop 0
    v_readlane_b32 s94, v33, 7
    s_nop 1
    s_cmp_ge_u32 s94, 256
    s_nop 1
    s_cbranch_scc1 L2_cdone
    s_sub_u32 s95, s95, 1
    s_cmp_lg_u32 s95, 0
    s_cbranch_scc1 L2_cpoll
L2_cdone:
    v_cmp_gt_u32 vcc, s92, v30
    s_nop 1
    v_cndmask_b32 v33, 0, v32, vcc
    s_nop 1
    v_add_u32_dpp v33, v33, v33 row_shr:1 row_mask:0xf bank_mask:0xf bound_ctrl:0
    s_nop 1
    v_add_u32_dpp v33, v33, v33 row_shr:2 row_mask:0xf bank_mask:0xf bound_ctrl:0
    s_nop 1
    v_add_u32_dpp v33, v33, v33 row_shr:4 row_mask:0xf bank_mask:0xf bound_ctrl:0
    s_nop 0
    v_readlane_b32 s94, v33, 7
    v_readlane_b32 s95, v32, 0
    s_nop 0
    s_add_u32 s90, s89, s94
    s_cmp_ge_u32 s95, 32
    s_cselect_b32 s91, 1, 0
L_c2done:
    s_mov_b32 s58, s91
    s_barrier
    s_cmp_lg_u32 s25, 0
    s_cbranch_scc1 C_noarr
    v_mov_b32 v30, 0
    v_mov_b32 v31, 1
    s_mov_b64 exec, 1
    buffer_atomic_add v31, v30, s[40:43], 0 offen
    s_mov_b64 exec, -1
C_noarr:
    s_mov_b32 s20, s72
    s_mov_b32 s21, s73
    s_mov_b32 s22, 8192
    s_mov_b32 s23, 0x20000
    v_and_b32 v134, 63, v0
    v_bfe_u32 v135, v134, 2, 2
    v_lshlrev_b32 v135, 1, v135
    v_and_b32 v137, 1, v134
    v_add_u32 v135, v135, v137
    v_lshlrev_b32 v135, 10, v135
    v_bfe_u32 v137, v134, 1, 1
    v_lshl_add_u32 v135, v137, 7, v135
    v_bfe_u32 v137, v134, 4, 2
    v_lshl_add_u32 v135, v137, 3, v135
    s_lshl_b32 s34, s25, 8
    buffer_load_dword v62, v135, s[20:23], s34 offen offset:0
    buffer_load_dword v63, v135, s[20:23], s34 offen offset:32
    buffer_load_dword v64, v135, s[20:23], s34 offen offset:4
    buffer_load_dword v65, v135, s[20:23], s34 offen offset:36
    buffer_load_dword v66, v135, s[20:23], s34 offen offset:64
    buffer_load_dword v67, v135, s[20:23], s34 offen offset:96
    buffer_load_dword v68, v135, s[20:23], s34 offen offset:68
    buffer_load_dword v69, v135, s[20:23], s34 offen offset:100
    s_mov_b32 s35, 0x05040100
    s_mov_b32 s36, 0x07060302
    s_waitcnt vmcnt(6)
    v_perm_b32 v30, v63, v62, s35
    v_perm_b32 v31, v63, v62, s36
    s_waitcnt vmcnt(4)
    v_perm_b32 v32, v65, v64, s35
    v_perm_b32 v33, v65, v64, s36
    s_waitcnt vmcnt(2)
    v_perm_b32 v34, v67, v66, s35
    v_perm_b32 v35, v67, v66, s36
    s_waitcnt vmcnt(0)
    v_perm_b32 v36, v69, v68, s35
    v_perm_b32 v37, v69, v68, s36
    ds_write_b128 v1, v[30:33] offset:0
    ds_write_b128 v1, v[34:37] offset:1024
    s_mov_b32 s34, 512
    s_mov_b32 s35, 224
    v_mov_b32 v134, 0
C_wkv:
    buffer_load_dword v135, v134, s[40:43], s34 offen sc1
    s_waitcnt vmcnt(0)
    v_readfirstlane_b32 s36, v135
    s_nop 1
    s_cmp_ge_u32 s36, s35
    s_nop 1
    s_cbranch_scc1 C_wkv_ok
    s_cmp_eq_u32 s33, 0
    s_cbranch_scc1 C_wkv_ok
    s_sub_u32 s33, s33, 1
    s_sleep 2
    s_branch C_wkv
C_wkv_ok:
    s_mov_b32 s34, 0
    s_mov_b32 s35, 32
    v_mov_b32 v134, 0
C_wrdy:
    buffer_load_dword v135, v134, s[40:43], s34 offen sc1
    s_waitcnt vmcnt(0)
    v_readfirstlane_b32 s36, v135
    s_nop 1
    s_cmp_ge_u32 s36, s35
    s_nop 1
    s_cbranch_scc1 C_wrdy_ok
    s_cmp_eq_u32 s33, 0
    s_cbranch_scc1 C_wrdy_ok
    s_sub_u32 s33, s33, 1
    s_sleep 2
    s_branch C_wrdy
C_wrdy_ok:
    s_mov_b32 s26, 0
    s_lshl_b32 s39, s24, 7
    s_add_u32 s39, s39, 1024
    s_mov_b32 s27, 8192
    s_lshl_b32 s38, s24, 8
    s_add_u32 s38, s38, 16384
    s_mov_b32 s28, 0
    s_add_u32 s53, s59, 524288
    s_lshl_b32 s34, s24, 2
    s_add_u32 s34, s34, s25
    s_lshl_b32 s32, s34, 11
    s_lshl_b32 s34, s34, 12
    buffer_load_dwordx4 v[118:121], v2, s[12:15], s34 offen offset:0
    buffer_load_dwordx4 v[122:125], v2, s[12:15], s34 offen offset:1024
    buffer_load_dwordx4 v[126:129], v2, s[12:15], s34 offen offset:2048
    buffer_load_dwordx4 v[130:133], v2, s[12:15], s34 offen offset:3072
    s_mov_b32 s98, s34
    s_add_u32 s30, s34, 524288
    s_lshl_b32 s35, s24, 2
    s_and_b32 s36, s25, 1
    s_lshl_b32 s36, s36, 1
    s_add_u32 s35, s35, s36
    s_lshl_b32 s35, s35, 12
    s_add_u32 s31, s35, 1048576
    s_cmp_ge_u32 s25, 2
    s_cselect_b32 s54, -1, 0
    s_mov_b32 s55, s54
    v_mov_b64 v[94:95], 0
    v_mov_b64 v[96:97], 0
    v_mov_b64 v[98:99], 0
    v_mov_b64 v[100:101], 0
    v_mov_b64 v[102:103], 0
    v_mov_b64 v[104:105], 0
    v_mov_b64 v[106:107], 0
    v_mov_b64 v[108:109], 0
    v_mov_b64 v[110:111], 0
    v_mov_b64 v[112:113], 0
    v_mov_b64 v[114:115], 0
    v_mov_b64 v[116:117], 0
    ds_read_b128 v[62:65], v3 offset:0
    ds_read_b128 v[66:69], v3 offset:1024
    ds_read_b128 v[70:73], v3 offset:2048
    ds_read_b128 v[74:77], v3 offset:3072
    ds_read_b128 v[78:81], v3 offset:16384
    ds_read_b128 v[82:85], v3 offset:17408
    ds_read_b128 v[86:89], v3 offset:18432
    ds_read_b128 v[90:93], v3 offset:19456
    v_mov_b32 v138, -1
    v_mov_b32 v139, -1
    v_mov_b32 v140, -1
    v_mov_b32 v141, -1
    s_waitcnt vmcnt(0) lgkmcnt(0)
    s_barrier
    s_cmp_eq_u32 s58, 0
    s_cbranch_scc1 C_slow_step
C_fast_step:
    s_cmp_lg_u32 s26, 10
    s_cbranch_scc1 C_fast_nokvw
    s_mov_b32 s34, 256
    s_mov_b32 s35, 224
    v_mov_b32 v134, 0
C_fast_wkv2:
    buffer_load_dword v135, v134, s[40:43], s34 offen sc1
    s_waitcnt vmcnt(0)
    v_readfirstlane_b32 s36, v135
    s_nop 1
    s_cmp_ge_u32 s36, s35
    s_nop 1
    s_cbranch_scc1 C_fast_wkv2_ok
    s_cmp_eq_u32 s33, 0
    s_cbranch_scc1 C_fast_wkv2_ok
    s_sub_u32 s33, s33, 1
    s_sleep 2
    s_branch C_fast_wkv2
C_fast_wkv2_ok:
C_fast_nokvw:
    ds_read_b128 v[30:33], v2 offset:0
    ds_read_b128 v[34:37], v2 offset:1024
    ds_read_b128 v[38:41], v2 offset:2048
    s_mov_b64 exec, s[54:55]
    buffer_load_dword v143, v12, s[12:15], s31 offen
    s_mov_b64 exec, -1
    s_waitcnt lgkmcnt(2)
    v_smfmac_f32_16x16x64_bf16 v[94:97], v[30:33], v[62:69], v11
    ds_read_b128 v[42:45], v2 offset:3072
    v_smfmac_f32_16x16x64_bf16 v[98:101], v[30:33], v[70:77], v11
    ds_read_b128 v[46:49], v2 offset:4096
    s_waitcnt lgkmcnt(3)
    v_smfmac_f32_16x16x64_bf16 v[94:97], v[34:37], v[78:85], v11
    ds_read_b128 v[50:53], v2 offset:5120
    v_smfmac_f32_16x16x64_bf16 v[98:101], v[34:37], v[86:93], v11
    ds_read_b128 v[54:57], v2 offset:6144
    s_waitcnt lgkmcnt(4)
    v_smfmac_f32_16x16x64_bf16 v[94:97], v[38:41], a[0:7], v11
    ds_read_b128 v[58:61], v2 offset:7168
    v_smfmac_f32_16x16x64_bf16 v[98:101], v[38:41], a[8:15], v11
    ds_read_b128 v[62:65], v3 offset:32768
    s_waitcnt lgkmcnt(5)
    v_smfmac_f32_16x16x64_bf16 v[94:97], v[42:45], a[16:23], v11
    ds_read_b128 v[66:69], v3 offset:33792
    v_smfmac_f32_16x16x64_bf16 v[98:101], v[42:45], a[24:31], v11
    ds_read_b128 v[70:73], v3 offset:34816
    s_waitcnt lgkmcnt(6)
    v_smfmac_f32_16x16x64_bf16 v[94:97], v[46:49], a[32:39], v11
    ds_read_b128 v[74:77], v3 offset:35840
    v_smfmac_f32_16x16x64_bf16 v[98:101], v[46:49], a[40:47], v11
    ds_read_b128 v[78:81], v3 offset:49152
    s_waitcnt lgkmcnt(7)
    v_smfmac_f32_16x16x64_bf16 v[94:97], v[50:53], a[48:55], v11
    ds_read_b128 v[82:85], v3 offset:50176
    v_smfmac_f32_16x16x64_bf16 v[98:101], v[50:53], a[56:63], v11
    ds_read_b128 v[86:89], v3 offset:51200
    s_waitcnt lgkmcnt(8)
    v_smfmac_f32_16x16x64_bf16 v[94:97], v[54:57], a[64:71], v11
    ds_read_b128 v[90:93], v3 offset:52224
    v_smfmac_f32_16x16x64_bf16 v[98:101], v[54:57], a[72:79], v11
    v_mov_b32 v142, s26
    s_waitcnt lgkmcnt(8)
    v_smfmac_f32_16x16x64_bf16 v[94:97], v[58:61], a[80:87], v11
    buffer_store_dword v142, v17, s[40:43], s39 offen sc1
    v_smfmac_f32_16x16x64_bf16 v[98:101], v[58:61], a[88:95], v11
    v_smfmac_f32_16x16x64_bf16 v[102:105], v[30:33], a[96:103], v11
    buffer_store_dwordx4 v[138:141], v2, s[4:7], s53 offen offset:0
    v_smfmac_f32_16x16x64_bf16 v[106:109], v[30:33], a[104:111], v11
    v_add_f32 v94, v94, v96
    v_smfmac_f32_16x16x64_bf16 v[102:105], v[34:37], a[112:119], v11
    v_add_f32 v95, v95, v97
    v_smfmac_f32_16x16x64_bf16 v[106:109], v[34:37], a[120:127], v11
    v_cvt_pk_bf16_f32 v16, v94, v95
    v_smfmac_f32_16x16x64_bf16 v[102:105], v[38:41], a[128:135], v11
    v_add_f32 v98, v98, v100
    v_smfmac_f32_16x16x64_bf16 v[106:109], v[38:41], a[136:143], v11
    v_add_f32 v99, v99, v101
    v_smfmac_f32_16x16x64_bf16 v[102:105], v[42:45], a[144:151], v11
    v_cvt_pk_bf16_f32 v18, v98, v99
    buffer_store_dwordx4 v[138:141], v2, s[4:7], s53 offen offset:1024
    v_smfmac_f32_16x16x64_bf16 v[106:109], v[42:45], a[152:159], v11
    v_mfma_f32_16x16x16_bf16 v[94:97], v[16:17], v[14:15], 0
    v_mfma_f32_16x16x16_bf16 v[98:101], v[18:19], v[14:15], 0
    v_smfmac_f32_16x16x64_bf16 v[102:105], v[46:49], a[160:167], v11
    buffer_store_dword v138, v13, s[8:11], s38 offen
    v_smfmac_f32_16x16x64_bf16 v[106:109], v[46:49], a[168:175], v11
    v_cvt_pk_bf16_f32 v134, v94, v95
    v_cvt_pk_bf16_f32 v135, v96, v97
    v_smfmac_f32_16x16x64_bf16 v[102:105], v[50:53], a[176:183], v11
    v_cvt_pk_bf16_f32 v136, v98, v99
    v_cvt_pk_bf16_f32 v137, v100, v101
    v_smfmac_f32_16x16x64_bf16 v[106:109], v[50:53], a[184:191], v11
    v_mfma_f32_16x16x32_bf16 v[94:97], v[118:121], v[134:137], 0
    v_mfma_f32_16x16x32_bf16 v[98:101], v[122:125], v[134:137], 0
    s_waitcnt lgkmcnt(6)
    v_smfmac_f32_16x16x64_bf16 v[102:105], v[54:57], v[62:69], v11
    s_waitcnt lgkmcnt(4)
    v_smfmac_f32_16x16x64_bf16 v[106:109], v[54:57], v[70:77], v11
    v_cndmask_b32 v94, v94, v98, s[46:47]
    v_cndmask_b32 v95, v95, v99, s[46:47]
    s_waitcnt lgkmcnt(2)
    v_smfmac_f32_16x16x64_bf16 v[102:105], v[58:61], v[78:85], v11
    v_cndmask_b32 v96, v96, v100, s[46:47]
    v_cndmask_b32 v97, v97, v101, s[46:47]
    s_waitcnt lgkmcnt(0)
    v_smfmac_f32_16x16x64_bf16 v[106:109], v[58:61], v[86:93], v11
    ds_write_b128 v1, v[94:97] offset:8192
    v_smfmac_f32_16x16x64_bf16 v[110:113], v[30:33], a[192:199], v11
    ds_read_b128 v[62:65], v7 offset:0
    v_smfmac_f32_16x16x64_bf16 v[114:117], v[30:33], a[200:207], v11
    v_add_f32 v102, v102, v104
    v_add_f32 v103, v103, v105
    v_cvt_pk_bf16_f32 v16, v102, v103
    v_smfmac_f32_16x16x64_bf16 v[110:113], v[34:37], a[208:215], v11
    v_add_f32 v106, v106, v108
    v_add_f32 v107, v107, v109
    v_cvt_pk_bf16_f32 v18, v106, v107
    v_smfmac_f32_16x16x64_bf16 v[114:117], v[34:37], a[216:223], v11
    v_mfma_f32_16x16x16_bf16 v[102:105], v[16:17], v[14:15], 0
    v_mfma_f32_16x16x16_bf16 v[106:109], v[18:19], v[14:15], 0
    ds_read_b128 v[66:69], v7 offset:1024
    ds_read_b128 v[70:73], v7 offset:2048
    v_smfmac_f32_16x16x64_bf16 v[110:113], v[38:41], a[224:231], v11
    ds_read_b128 v[74:77], v7 offset:3072
    v_smfmac_f32_16x16x64_bf16 v[114:117], v[38:41], a[232:239], v11
    v_cvt_pk_bf16_f32 v138, v102, v103
    v_cvt_pk_bf16_f32 v139, v104, v105
    v_smfmac_f32_16x16x64_bf16 v[110:113], v[42:45], a[240:247], v11
    v_cvt_pk_bf16_f32 v140, v106, v107
    v_cvt_pk_bf16_f32 v141, v108, v109
    v_smfmac_f32_16x16x64_bf16 v[114:117], v[42:45], a[248:255], v11
    v_mfma_f32_16x16x32_bf16 v[102:105], v[138:141], v[134:137], 0
    ds_read_b128 v[78:81], v7 offset:16384
    ds_read_b128 v[82:85], v7 offset:17408
    v_smfmac_f32_16x16x64_bf16 v[110:113], v[46:49], v[144:151], v11
    ds_read_b128 v[86:89], v7 offset:18432
    v_smfmac_f32_16x16x64_bf16 v[114:117], v[46:49], v[152:159], v11
    ds_read_b128 v[90:93], v7 offset:19456
    v_smfmac_f32_16x16x64_bf16 v[110:113], v[50:53], v[160:167], v11
    ds_write_b64 v1, v[102:103] offset:9216
    v_smfmac_f32_16x16x64_bf16 v[114:117], v[50:53], v[168:175], v11
    buffer_load_dwordx4 v[118:121], v2, s[12:15], s30 offen offset:0
    s_waitcnt lgkmcnt(7)
    v_smfmac_f32_16x16x64_bf16 v[110:113], v[54:57], v[62:69], v11
    buffer_load_dwordx4 v[122:125], v2, s[12:15], s30 offen offset:1024
    s_waitcnt lgkmcnt(5)
    v_smfmac_f32_16x16x64_bf16 v[114:117], v[54:57], v[70:77], v11
    buffer_store_dwordx4 v[138:141], v2, s[16:19], s32 offen sc1
    s_waitcnt lgkmcnt(3)
    v_smfmac_f32_16x16x64_bf16 v[110:113], v[58:61], v[78:85], v11
    s_waitcnt lgkmcnt(1)
    v_smfmac_f32_16x16x64_bf16 v[114:117], v[58:61], v[86:93], v11
    s_waitcnt lgkmcnt(0)
    s_barrier
    ds_read_b128 v[30:33], v2 offset:8192
    ds_read_b128 v[34:37], v2 offset:10240
    ds_read_b128 v[38:41], v2 offset:12288
    ds_read_b128 v[42:45], v2 offset:14336
    ds_read_b64 v[46:47], v2 offset:9216
    ds_read_b64 v[48:49], v2 offset:11264
    ds_read_b64 v[50:51], v2 offset:13312
    ds_read_b64 v[52:53], v2 offset:15360
    v_add_f32 v110, v110, v112
    v_add_f32 v111, v111, v113
    v_cvt_pk_bf16_f32 v16, v110, v111
    v_add_f32 v114, v114, v116
    v_add_f32 v115, v115, v117
    v_cvt_pk_bf16_f32 v18, v114, v115
    buffer_store_dword v16, v13, s[16:19], s32 offen offset:1024 sc1
    buffer_store_dword v18, v13, s[16:19], s32 offen offset:1280 sc1
    s_cmp_eq_u32 s26, 63
    s_cbranch_scc1 C_fast_last
    s_waitcnt lgkmcnt(6)
    v_pk_add_f32 v[30:31], v[30:31], v[34:35]
    v_pk_add_f32 v[32:33], v[32:33], v[36:37]
    s_waitcnt lgkmcnt(4)
    v_pk_add_f32 v[38:39], v[38:39], v[42:43]
    v_pk_add_f32 v[40:41], v[40:41], v[44:45]
    v_pk_add_f32 v[134:135], v[30:31], v[38:39]
    v_pk_add_f32 v[136:137], v[32:33], v[40:41]
    s_waitcnt lgkmcnt(2)
    v_pk_add_f32 v[46:47], v[46:47], v[48:49]
    s_waitcnt lgkmcnt(0)
    v_pk_add_f32 v[50:51], v[50:51], v[52:53]
    v_pk_add_f32 v[138:139], v[46:47], v[50:51]
    v_max3_f32 v140, v134, v135, v136
    v_max3_f32 v141, v137, v138, v139
    v_max_f32 v140, v140, v141
    ds_read_b128 v[62:65], v7 offset:32768
    ds_read_b128 v[66:69], v7 offset:33792
    v_max_f32_dpp v140, v140, v140 quad_perm:[2,3,0,1] row_mask:0xf bank_mask:0xf
    v_mov_b32 v141, v140
    ds_read_b128 v[70:73], v7 offset:34816
    ds_read_b128 v[74:77], v7 offset:35840
    v_permlane16_swap_b32 v141, v140
    v_max_f32 v140, v140, v141
    v_mov_b32 v141, v140
    ds_read_b128 v[78:81], v7 offset:49152
    ds_read_b128 v[82:85], v7 offset:50176
    v_permlane32_swap_b32 v141, v140
    v_max_f32 v140, v140, v141
    v_mul_f32 v140, s50, v140
    v_fma_f32 v138, v138, s50, -v140
    v_fma_f32 v139, v139, s50, -v140
    v_fma_f32 v134, v134, s50, -v140
    v_fma_f32 v135, v135, s50, -v140
    v_fma_f32 v136, v136, s50, -v140
    v_fma_f32 v137, v137, s50, -v140
    v_exp_f32 v138, v138
    v_exp_f32 v139, v139
    v_exp_f32 v134, v134
    v_exp_f32 v135, v135
    v_exp_f32 v136, v136
    v_exp_f32 v137, v137
    v_cvt_pk_bf16_f32 v28, v138, v139
    v_cvt_pk_bf16_f32 v94, v134, v135
    v_cvt_pk_bf16_f32 v95, v136, v137
    v_mfma_f32_16x16x16_bf16 v[102:105], v[20:21], v[28:29], 0
    v_mov_b32_dpp v96, v94 quad_perm:[2,3,0,1] row_mask:0xf bank_mask:0xf bound_ctrl:0
    v_mov_b32_dpp v97, v95 quad_perm:[2,3,0,1] row_mask:0xf bank_mask:0xf bound_ctrl:0
    v_mfma_f32_16x16x16_bf16 v[110:113], v[16:17], v[28:29], 0
    v_mfma_f32_16x16x32_bf16 v[102:105], v[20:23], v[94:97], v[102:105]
    v_mfma_f32_16x16x16_bf16 v[114:117], v[18:19], v[28:29], 0
    ds_read_b128 v[86:89], v7 offset:51200
    v_mfma_f32_16x16x32_bf16 v[110:113], v[126:129], v[94:97], v[110:113]
    ds_read_b128 v[90:93], v7 offset:52224
    v_mfma_f32_16x16x32_bf16 v[114:117], v[130:133], v[94:97], v[114:117]
    v_rcp_f32 v142, v102
    buffer_load_dwordx4 v[126:129], v2, s[12:15], s30 offen offset:2048
    buffer_load_dwordx4 v[130:133], v2, s[12:15], s30 offen offset:3072
    v_mov_b64 v[30:31], 0
    v_mov_b64 v[32:33], 0
    v_mov_b64 v[34:35], 0
    v_mov_b64 v[36:37], 0
    v_mul_f32 v110, v110, v142
    v_mul_f32 v111, v111, v142
    v_mul_f32 v112, v112, v142
    v_mul_f32 v113, v113, v142
    v_mul_f32 v114, v114, v142
    v_mul_f32 v115, v115, v142
    v_mul_f32 v116, v116, v142
    v_mul_f32 v117, v117, v142
    v_cvt_pk_bf16_f32 v134, v110, v111
    v_cvt_pk_bf16_f32 v135, v112, v113
    v_cvt_pk_bf16_f32 v136, v114, v115
    v_cvt_pk_bf16_f32 v137, v116, v117
    s_mov_b64 exec, s[48:49]
    ds_write_b64 v10, v[134:135] offset:0
    ds_write_b64 v10, v[136:137] offset:32
    s_mov_b64 exec, -1
    v_mov_b64 v[38:39], 0
    v_mov_b64 v[40:41], 0
    v_mov_b64 v[42:43], 0
    v_mov_b64 v[44:45], 0
    v_mov_b64 v[46:47], 0
    v_mov_b64 v[48:49], 0
    v_mov_b64 v[50:51], 0
    v_mov_b64 v[52:53], 0
    v_mov_b64 v[54:55], 0
    v_mov_b64 v[56:57], 0
    v_mov_b64 v[58:59], 0
    v_mov_b64 v[60:61], 0
    s_add_u32 s52, s28, 32768
    s_add_u32 s29, s28, 4096
    s_add_u32 s96, s28, 36864
    s_waitcnt lgkmcnt(0)
    s_barrier
    ds_read_b128 v[94:97], v2 offset:0
    ds_read_b128 v[98:101], v2 offset:1024
    s_waitcnt lgkmcnt(1)
    v_smfmac_f32_16x16x64_bf16 v[30:33], v[94:97], v[62:69], v11
    v_smfmac_f32_16x16x64_bf16 v[34:37], v[94:97], v[70:77], v11
    ds_read_b128 v[62:65], v8 offset:0
    ds_read_b128 v[66:69], v8 offset:1024
    s_waitcnt lgkmcnt(2)
    v_smfmac_f32_16x16x64_bf16 v[30:33], v[98:101], v[78:85], v11
    ds_read_b128 v[70:73], v8 offset:2048
    v_smfmac_f32_16x16x64_bf16 v[34:37], v[98:101], v[86:93], v11
    ds_read_b128 v[74:77], v8 offset:3072
    v_smfmac_f32_16x16x64_bf16 v[38:41], v[94:97], v[176:183], v11
    v_smfmac_f32_16x16x64_bf16 v[42:45], v[94:97], v[184:191], v11
    v_add_f32 v30, v30, v32
    v_add_f32 v31, v31, v33
    v_smfmac_f32_16x16x64_bf16 v[38:41], v[98:101], v[192:199], v11
    v_add_f32 v34, v34, v36
    v_add_f32 v35, v35, v37
    v_smfmac_f32_16x16x64_bf16 v[42:45], v[98:101], v[200:207], v11
    v_cvt_pk_bf16_f32 v30, v30, v31
    v_cvt_pk_bf16_f32 v31, v34, v35
    v_smfmac_f32_16x16x64_bf16 v[46:49], v[94:97], v[208:215], v11
    buffer_store_dwordx2 v[30:31], v4, s[4:7], s28 offen
    v_smfmac_f32_16x16x64_bf16 v[50:53], v[94:97], v[216:223], v11
    v_add_f32 v38, v38, v40
    v_add_f32 v39, v39, v41
    v_smfmac_f32_16x16x64_bf16 v[46:49], v[98:101], v[224:231], v11
    v_add_f32 v42, v42, v44
    v_add_f32 v43, v43, v45
    v_smfmac_f32_16x16x64_bf16 v[50:53], v[98:101], v[232:239], v11
    v_cvt_pk_bf16_f32 v38, v38, v39
    v_cvt_pk_bf16_f32 v39, v42, v43
    v_smfmac_f32_16x16x64_bf16 v[54:57], v[94:97], v[240:247], v11
    buffer_store_dwordx2 v[38:39], v4, s[4:7], s52 offen
    v_smfmac_f32_16x16x64_bf16 v[58:61], v[94:97], v[248:255], v11
    v_add_f32 v46, v46, v48
    v_add_f32 v47, v47, v49
    s_waitcnt lgkmcnt(2)
    v_smfmac_f32_16x16x64_bf16 v[54:57], v[98:101], v[62:69], v11
    v_add_f32 v50, v50, v52
    v_add_f32 v51, v51, v53
    s_waitcnt lgkmcnt(0)
    v_smfmac_f32_16x16x64_bf16 v[58:61], v[98:101], v[70:77], v11
    v_cvt_pk_bf16_f32 v46, v46, v47
    v_cvt_pk_bf16_f32 v47, v50, v51
    buffer_store_dwordx2 v[46:47], v4, s[4:7], s29 offen
    v_mov_b64 v[102:103], 0
    v_mov_b64 v[104:105], 0
    v_mov_b64 v[106:107], 0
    v_mov_b64 v[108:109], 0
    v_mov_b64 v[110:111], 0
    v_mov_b64 v[112:113], 0
    v_mov_b64 v[114:115], 0
    v_mov_b64 v[116:117], 0
    v_add_f32 v54, v54, v56
    v_add_f32 v55, v55, v57
    v_add_f32 v58, v58, v60
    v_add_f32 v59, v59, v61
    v_cvt_pk_bf16_f32 v54, v54, v55
    v_cvt_pk_bf16_f32 v55, v58, v59
    buffer_store_dwordx2 v[54:55], v4, s[4:7], s96 offen
    v_mov_b64 v[94:95], 0
    v_mov_b64 v[96:97], 0
    v_mov_b64 v[98:99], 0
    v_mov_b64 v[100:101], 0
    ds_read_b128 v[62:65], v3 offset:0
    ds_read_b128 v[66:69], v3 offset:1024
    ds_read_b128 v[70:73], v3 offset:2048
    ds_read_b128 v[74:77], v3 offset:3072
    ds_read_b128 v[78:81], v3 offset:16384
    ds_read_b128 v[82:85], v3 offset:17408
    ds_read_b128 v[86:89], v3 offset:18432
    ds_read_b128 v[90:93], v3 offset:19456
    s_cmp_lt_u32 s25, 1
    s_cbranch_scc1 C_fast_noack
    s_waitcnt vmcnt(0)
C_fast_noack:
    s_mov_b32 s51, s27
    s_add_u32 s26, s26, 1
    s_cmp_ge_u32 s25, 2
    s_cbranch_scc1 C_fast_nored
    buffer_load_dwordx4 v[30:33], v5, s[4:7], s28 offen offset:0 sc1
    buffer_load_dwordx4 v[34:37], v5, s[4:7], s28 offen offset:1024 sc1
    buffer_load_dwordx4 v[38:41], v5, s[4:7], s28 offen offset:2048 sc1
    buffer_load_dwordx4 v[42:45], v5, s[4:7], s28 offen offset:3072 sc1
C_fast_r_poll:
    s_waitcnt vmcnt(3)
    v_mfma_f32_16x16x32_bf16 v[136:139], v[24:27], v[30:33], 0
    s_waitcnt vmcnt(2)
    v_mfma_f32_16x16x32_bf16 v[136:139], v[24:27], v[34:37], v[136:139]
    s_waitcnt vmcnt(1)
    v_mfma_f32_16x16x32_bf16 v[136:139], v[24:27], v[38:41], v[136:139]
    s_waitcnt vmcnt(0)
    v_mfma_f32_16x16x32_bf16 v[136:139], v[24:27], v[42:45], v[136:139]
    s_nop 7
    v_cmp_u_f32 vcc, v136, v137
    v_cmp_u_f32 s[60:61], v138, v139
    v_add_f32_dpp v136, v136, v136 row_ror:8 row_mask:0xf bank_mask:0xf
    v_add_f32_dpp v137, v137, v137 row_ror:8 row_mask:0xf bank_mask:0xf
    v_add_f32_dpp v138, v138, v138 row_ror:8 row_mask:0xf bank_mask:0xf
    v_add_f32_dpp v139, v139, v139 row_ror:8 row_mask:0xf bank_mask:0xf
    s_or_b64 vcc, vcc, s[60:61]
    s_nop 0
    s_cbranch_scc0 C_fast_r_ok
    v_max3_u32 v134, v30, v31, v32
    v_max_u32 v134, v134, v33
    v_cmp_eq_u32 s[60:61], -1, v134
    v_max3_u32 v134, v34, v35, v36
    v_max_u32 v134, v134, v37
    v_cmp_eq_u32 s[62:63], -1, v134
    v_max3_u32 v134, v38, v39, v40
    v_max_u32 v134, v134, v41
    v_cmp_eq_u32 s[56:57], -1, v134
    v_max3_u32 v134, v42, v43, v44
    v_max_u32 v134, v134, v45
    v_cmp_eq_u32 s[36:37], -1, v134
    s_or_b64 vcc, s[60:61], s[62:63]
    s_or_b64 vcc, vcc, s[56:57]
    s_or_b64 vcc, vcc, s[36:37]
    s_nop 1
    s_cbranch_scc0 C_fast_r_ok
    s_cmp_eq_u32 s33, 0
    s_cbranch_scc1 C_fast_r_ok
    s_sub_u32 s33, s33, 1
    s_mov_b64 exec, s[60:61]
    buffer_load_dwordx4 v[30:33], v5, s[4:7], s28 offen offset:0 sc1
    s_mov_b64 exec, s[62:63]
    buffer_load_dwordx4 v[34:37], v5, s[4:7], s28 offen offset:1024 sc1
    s_mov_b64 exec, s[56:57]
    buffer_load_dwordx4 v[38:41], v5, s[4:7], s28 offen offset:2048 sc1
    s_mov_b64 exec, s[36:37]
    buffer_load_dwordx4 v[42:45], v5, s[4:7], s28 offen offset:3072 sc1
    s_mov_b64 exec, -1
    s_branch C_fast_r_poll
C_fast_r_ok:
    v_cvt_pk_bf16_f32 v136, v136, v138
    v_cvt_pk_bf16_f32 v137, v137, v139
    v_cndmask_b32 v136, v136, v137, s[44:45]
    v_min_u32 v136, -2, v136
    s_mov_b32 exec_hi, 0
    buffer_store_dword v136, v6, s[8:11], s51 offen
    s_mov_b32 exec_hi, -1
C_fast_nored:
    s_barrier
    s_add_u32 s27, s27, 8192
    s_cmp_eq_u32 s27, 24576
    s_cselect_b32 s27, 0, s27
    s_add_u32 s34, s27, 8192
    s_cmp_eq_u32 s34, 24576
    s_cselect_b32 s34, 0, s34
    s_lshl_b32 s38, s24, 8
    s_add_u32 s38, s38, s34
    s_add_u32 s53, s59, s28
    s_add_u32 s28, s28, 262144
    s_cmp_eq_u32 s28, 786432
    s_cselect_b32 s28, 0, s28
    s_add_u32 s30, s30, 524288
    s_add_u32 s31, s31, 524288
    s_add_u32 s32, s32, 262144
    v_mov_b32 v138, -1
    v_mov_b32 v139, -1
    v_mov_b32 v140, -1
    v_mov_b32 v141, -1
    s_sleep 2
    buffer_load_dwordx4 v[30:33], v1, s[8:11], s51 offen sc1
    buffer_load_dwordx4 v[34:37], v1, s[8:11], s51 offen offset:1024 sc1
C_fast_g_poll:
    s_waitcnt vmcnt(1)
    v_max3_u32 v134, v30, v31, v32
    v_max_u32 v134, v134, v33
    v_cmp_eq_u32 s[60:61], -1, v134
    s_waitcnt vmcnt(0)
    v_max3_u32 v135, v34, v35, v36
    v_max_u32 v135, v135, v37
    v_cmp_eq_u32 s[62:63], -1, v135
    ds_write_b128 v1, v[30:33] offset:0
    ds_write_b128 v1, v[34:37] offset:1024
    s_or_b64 vcc, s[60:61], s[62:63]
    s_nop 1
    s_cbranch_scc0 C_fast_g_ok
    s_cmp_eq_u32 s33, 0
    s_cbranch_scc1 C_fast_g_ok
    s_sub_u32 s33, s33, 1
    s_mov_b64 exec, s[60:61]
    buffer_load_dwordx4 v[30:33], v1, s[8:11], s51 offen sc1
    s_mov_b64 exec, s[62:63]
    buffer_load_dwordx4 v[34:37], v1, s[8:11], s51 offen offset:1024 sc1
    s_mov_b64 exec, -1
    s_branch C_fast_g_poll
C_fast_g_ok:
    s_waitcnt vmcnt(0) lgkmcnt(0)
    s_barrier
    s_branch C_fast_step
C_fast_last:
    s_waitcnt vmcnt(0) lgkmcnt(0)
    s_barrier
    s_cmp_lg_u32 s25, 3
    s_cbranch_scc1 C_fast_end
    v_mov_b32 v134, 64
    s_lshl_b32 s34, s24, 7
    s_add_u32 s34, s34, 1024
    v_mov_b32 v135, 0
    s_mov_b64 exec, 1
    buffer_store_dword v134, v135, s[40:43], s34 offen sc1
    s_mov_b64 exec, -1
    s_waitcnt vmcnt(0)
C_fast_end:
    s_branch C_exit
C_slow_step:
    s_cmp_lg_u32 s26, 10
    s_cbranch_scc1 C_slow_nokvw
    s_mov_b32 s34, 256
    s_mov_b32 s35, 224
    v_mov_b32 v134, 0
C_slow_wkv2:
    buffer_load_dword v135, v134, s[40:43], s34 offen sc1
    s_waitcnt vmcnt(0)
    v_readfirstlane_b32 s36, v135
    s_nop 1
    s_cmp_ge_u32 s36, s35
    s_nop 1
    s_cbranch_scc1 C_slow_wkv2_ok
    s_cmp_eq_u32 s33, 0
    s_cbranch_scc1 C_slow_wkv2_ok
    s_sub_u32 s33, s33, 1
    s_sleep 2
    s_branch C_slow_wkv2
C_slow_wkv2_ok:
C_slow_nokvw:
    ds_read_b128 v[30:33], v2 offset:0
    ds_read_b128 v[34:37], v2 offset:1024
    ds_read_b128 v[38:41], v2 offset:2048
    s_mov_b64 exec, s[54:55]
    buffer_load_dword v143, v12, s[12:15], s31 offen
    s_mov_b64 exec, -1
    s_waitcnt lgkmcnt(2)
    v_smfmac_f32_16x16x64_bf16 v[94:97], v[30:33], v[62:69], v11
    ds_read_b128 v[42:45], v2 offset:3072
    v_smfmac_f32_16x16x64_bf16 v[98:101], v[30:33], v[70:77], v11
    ds_read_b128 v[46:49], v2 offset:4096
    s_waitcnt lgkmcnt(3)
    v_smfmac_f32_16x16x64_bf16 v[94:97], v[34:37], v[78:85], v11
    ds_read_b128 v[50:53], v2 offset:5120
    v_smfmac_f32_16x16x64_bf16 v[98:101], v[34:37], v[86:93], v11
    ds_read_b128 v[54:57], v2 offset:6144
    s_waitcnt lgkmcnt(4)
    v_smfmac_f32_16x16x64_bf16 v[94:97], v[38:41], a[0:7], v11
    ds_read_b128 v[58:61], v2 offset:7168
    v_smfmac_f32_16x16x64_bf16 v[98:101], v[38:41], a[8:15], v11
    ds_read_b128 v[62:65], v3 offset:32768
    s_waitcnt lgkmcnt(5)
    v_smfmac_f32_16x16x64_bf16 v[94:97], v[42:45], a[16:23], v11
    ds_read_b128 v[66:69], v3 offset:33792
    v_smfmac_f32_16x16x64_bf16 v[98:101], v[42:45], a[24:31], v11
    ds_read_b128 v[70:73], v3 offset:34816
    s_waitcnt lgkmcnt(6)
    v_smfmac_f32_16x16x64_bf16 v[94:97], v[46:49], a[32:39], v11
    ds_read_b128 v[74:77], v3 offset:35840
    v_smfmac_f32_16x16x64_bf16 v[98:101], v[46:49], a[40:47], v11
    ds_read_b128 v[78:81], v3 offset:49152
    s_waitcnt lgkmcnt(7)
    v_smfmac_f32_16x16x64_bf16 v[94:97], v[50:53], a[48:55], v11
    ds_read_b128 v[82:85], v3 offset:50176
    v_smfmac_f32_16x16x64_bf16 v[98:101], v[50:53], a[56:63], v11
    ds_read_b128 v[86:89], v3 offset:51200
    s_waitcnt lgkmcnt(8)
    v_smfmac_f32_16x16x64_bf16 v[94:97], v[54:57], a[64:71], v11
    ds_read_b128 v[90:93], v3 offset:52224
    v_smfmac_f32_16x16x64_bf16 v[98:101], v[54:57], a[72:79], v11
    v_mov_b32 v142, s26
    s_waitcnt lgkmcnt(8)
    v_smfmac_f32_16x16x64_bf16 v[94:97], v[58:61], a[80:87], v11
    buffer_store_dword v142, v17, s[40:43], s39 offen sc1
    v_smfmac_f32_16x16x64_bf16 v[98:101], v[58:61], a[88:95], v11
    v_smfmac_f32_16x16x64_bf16 v[102:105], v[30:33], a[96:103], v11
    buffer_store_dwordx4 v[138:141], v2, s[4:7], s53 offen offset:0 sc1
    v_smfmac_f32_16x16x64_bf16 v[106:109], v[30:33], a[104:111], v11
    v_add_f32 v94, v94, v96
    v_smfmac_f32_16x16x64_bf16 v[102:105], v[34:37], a[112:119], v11
    v_add_f32 v95, v95, v97
    v_smfmac_f32_16x16x64_bf16 v[106:109], v[34:37], a[120:127], v11
    v_cvt_pk_bf16_f32 v16, v94, v95
    v_smfmac_f32_16x16x64_bf16 v[102:105], v[38:41], a[128:135], v11
    v_add_f32 v98, v98, v100
    v_smfmac_f32_16x16x64_bf16 v[106:109], v[38:41], a[136:143], v11
    v_add_f32 v99, v99, v101
    v_smfmac_f32_16x16x64_bf16 v[102:105], v[42:45], a[144:151], v11
    v_cvt_pk_bf16_f32 v18, v98, v99
    buffer_store_dwordx4 v[138:141], v2, s[4:7], s53 offen offset:1024 sc1
    v_smfmac_f32_16x16x64_bf16 v[106:109], v[42:45], a[152:159], v11
    v_mfma_f32_16x16x16_bf16 v[94:97], v[16:17], v[14:15], 0
    v_mfma_f32_16x16x16_bf16 v[98:101], v[18:19], v[14:15], 0
    v_smfmac_f32_16x16x64_bf16 v[102:105], v[46:49], a[160:167], v11
    buffer_store_dword v138, v13, s[8:11], s38 offen sc1
    v_smfmac_f32_16x16x64_bf16 v[106:109], v[46:49], a[168:175], v11
    v_cvt_pk_bf16_f32 v134, v94, v95
    v_cvt_pk_bf16_f32 v135, v96, v97
    v_smfmac_f32_16x16x64_bf16 v[102:105], v[50:53], a[176:183], v11
    v_cvt_pk_bf16_f32 v136, v98, v99
    v_cvt_pk_bf16_f32 v137, v100, v101
    v_smfmac_f32_16x16x64_bf16 v[106:109], v[50:53], a[184:191], v11
    v_mfma_f32_16x16x32_bf16 v[94:97], v[118:121], v[134:137], 0
    v_mfma_f32_16x16x32_bf16 v[98:101], v[122:125], v[134:137], 0
    s_waitcnt lgkmcnt(6)
    v_smfmac_f32_16x16x64_bf16 v[102:105], v[54:57], v[62:69], v11
    s_waitcnt lgkmcnt(4)
    v_smfmac_f32_16x16x64_bf16 v[106:109], v[54:57], v[70:77], v11
    v_cndmask_b32 v94, v94, v98, s[46:47]
    v_cndmask_b32 v95, v95, v99, s[46:47]
    s_waitcnt lgkmcnt(2)
    v_smfmac_f32_16x16x64_bf16 v[102:105], v[58:61], v[78:85], v11
    v_cndmask_b32 v96, v96, v100, s[46:47]
    v_cndmask_b32 v97, v97, v101, s[46:47]
    s_waitcnt lgkmcnt(0)
    v_smfmac_f32_16x16x64_bf16 v[106:109], v[58:61], v[86:93], v11
    ds_write_b128 v1, v[94:97] offset:8192
    v_smfmac_f32_16x16x64_bf16 v[110:113], v[30:33], a[192:199], v11
    ds_read_b128 v[62:65], v7 offset:0
    v_smfmac_f32_16x16x64_bf16 v[114:117], v[30:33], a[200:207], v11
    v_add_f32 v102, v102, v104
    v_add_f32 v103, v103, v105
    v_cvt_pk_bf16_f32 v16, v102, v103
    v_smfmac_f32_16x16x64_bf16 v[110:113], v[34:37], a[208:215], v11
    v_add_f32 v106, v106, v108
    v_add_f32 v107, v107, v109
    v_cvt_pk_bf16_f32 v18, v106, v107
    v_smfmac_f32_16x16x64_bf16 v[114:117], v[34:37], a[216:223], v11
    v_mfma_f32_16x16x16_bf16 v[102:105], v[16:17], v[14:15], 0
    v_mfma_f32_16x16x16_bf16 v[106:109], v[18:19], v[14:15], 0
    ds_read_b128 v[66:69], v7 offset:1024
    ds_read_b128 v[70:73], v7 offset:2048
    v_smfmac_f32_16x16x64_bf16 v[110:113], v[38:41], a[224:231], v11
    ds_read_b128 v[74:77], v7 offset:3072
    v_smfmac_f32_16x16x64_bf16 v[114:117], v[38:41], a[232:239], v11
    v_cvt_pk_bf16_f32 v138, v102, v103
    v_cvt_pk_bf16_f32 v139, v104, v105
    v_smfmac_f32_16x16x64_bf16 v[110:113], v[42:45], a[240:247], v11
    v_cvt_pk_bf16_f32 v140, v106, v107
    v_cvt_pk_bf16_f32 v141, v108, v109
    v_smfmac_f32_16x16x64_bf16 v[114:117], v[42:45], a[248:255], v11
    v_mfma_f32_16x16x32_bf16 v[102:105], v[138:141], v[134:137], 0
    ds_read_b128 v[78:81], v7 offset:16384
    ds_read_b128 v[82:85], v7 offset:17408
    v_smfmac_f32_16x16x64_bf16 v[110:113], v[46:49], v[144:151], v11
    ds_read_b128 v[86:89], v7 offset:18432
    v_smfmac_f32_16x16x64_bf16 v[114:117], v[46:49], v[152:159], v11
    ds_read_b128 v[90:93], v7 offset:19456
    v_smfmac_f32_16x16x64_bf16 v[110:113], v[50:53], v[160:167], v11
    ds_write_b64 v1, v[102:103] offset:9216
    v_smfmac_f32_16x16x64_bf16 v[114:117], v[50:53], v[168:175], v11
    buffer_load_dwordx4 v[118:121], v2, s[12:15], s30 offen offset:0
    s_waitcnt lgkmcnt(7)
    v_smfmac_f32_16x16x64_bf16 v[110:113], v[54:57], v[62:69], v11
    buffer_load_dwordx4 v[122:125], v2, s[12:15], s30 offen offset:1024
    s_waitcnt lgkmcnt(5)
    v_smfmac_f32_16x16x64_bf16 v[114:117], v[54:57], v[70:77], v11
    buffer_store_dwordx4 v[138:141], v2, s[16:19], s32 offen sc1
    s_waitcnt lgkmcnt(3)
    v_smfmac_f32_16x16x64_bf16 v[110:113], v[58:61], v[78:85], v11
    s_waitcnt lgkmcnt(1)
    v_smfmac_f32_16x16x64_bf16 v[114:117], v[58:61], v[86:93], v11
    s_waitcnt lgkmcnt(0)
    s_barrier
    ds_read_b128 v[30:33], v2 offset:8192
    ds_read_b128 v[34:37], v2 offset:10240
    ds_read_b128 v[38:41], v2 offset:12288
    ds_read_b128 v[42:45], v2 offset:14336
    ds_read_b64 v[46:47], v2 offset:9216
    ds_read_b64 v[48:49], v2 offset:11264
    ds_read_b64 v[50:51], v2 offset:13312
    ds_read_b64 v[52:53], v2 offset:15360
    v_add_f32 v110, v110, v112
    v_add_f32 v111, v111, v113
    v_cvt_pk_bf16_f32 v16, v110, v111
    v_add_f32 v114, v114, v116
    v_add_f32 v115, v115, v117
    v_cvt_pk_bf16_f32 v18, v114, v115
    buffer_store_dword v16, v13, s[16:19], s32 offen offset:1024 sc1
    buffer_store_dword v18, v13, s[16:19], s32 offen offset:1280 sc1
    s_cmp_eq_u32 s26, 63
    s_cbranch_scc1 C_slow_last
    s_waitcnt lgkmcnt(6)
    v_pk_add_f32 v[30:31], v[30:31], v[34:35]
    v_pk_add_f32 v[32:33], v[32:33], v[36:37]
    s_waitcnt lgkmcnt(4)
    v_pk_add_f32 v[38:39], v[38:39], v[42:43]
    v_pk_add_f32 v[40:41], v[40:41], v[44:45]
    v_pk_add_f32 v[134:135], v[30:31], v[38:39]
    v_pk_add_f32 v[136:137], v[32:33], v[40:41]
    s_waitcnt lgkmcnt(2)
    v_pk_add_f32 v[46:47], v[46:47], v[48:49]
    s_waitcnt lgkmcnt(0)
    v_pk_add_f32 v[50:51], v[50:51], v[52:53]
    v_pk_add_f32 v[138:139], v[46:47], v[50:51]
    v_max3_f32 v140, v134, v135, v136
    v_max3_f32 v141, v137, v138, v139
    v_max_f32 v140, v140, v141
    ds_read_b128 v[62:65], v7 offset:32768
    ds_read_b128 v[66:69], v7 offset:33792
    v_max_f32_dpp v140, v140, v140 quad_perm:[2,3,0,1] row_mask:0xf bank_mask:0xf
    v_mov_b32 v141, v140
    ds_read_b128 v[70:73], v7 offset:34816
    ds_read_b128 v[74:77], v7 offset:35840
    v_permlane16_swap_b32 v141, v140
    v_max_f32 v140, v140, v141
    v_mov_b32 v141, v140
    ds_read_b128 v[78:81], v7 offset:49152
    ds_read_b128 v[82:85], v7 offset:50176
    v_permlane32_swap_b32 v141, v140
    v_max_f32 v140, v140, v141
    v_mul_f32 v140, s50, v140
    v_fma_f32 v138, v138, s50, -v140
    v_fma_f32 v139, v139, s50, -v140
    v_fma_f32 v134, v134, s50, -v140
    v_fma_f32 v135, v135, s50, -v140
    v_fma_f32 v136, v136, s50, -v140
    v_fma_f32 v137, v137, s50, -v140
    v_exp_f32 v138, v138
    v_exp_f32 v139, v139
    v_exp_f32 v134, v134
    v_exp_f32 v135, v135
    v_exp_f32 v136, v136
    v_exp_f32 v137, v137
    v_cvt_pk_bf16_f32 v28, v138, v139
    v_cvt_pk_bf16_f32 v94, v134, v135
    v_cvt_pk_bf16_f32 v95, v136, v137
    v_mfma_f32_16x16x16_bf16 v[102:105], v[20:21], v[28:29], 0
    v_mov_b32_dpp v96, v94 quad_perm:[2,3,0,1] row_mask:0xf bank_mask:0xf bound_ctrl:0
    v_mov_b32_dpp v97, v95 quad_perm:[2,3,0,1] row_mask:0xf bank_mask:0xf bound_ctrl:0
    v_mfma_f32_16x16x16_bf16 v[110:113], v[16:17], v[28:29], 0
    v_mfma_f32_16x16x32_bf16 v[102:105], v[20:23], v[94:97], v[102:105]
    v_mfma_f32_16x16x16_bf16 v[114:117], v[18:19], v[28:29], 0
    ds_read_b128 v[86:89], v7 offset:51200
    v_mfma_f32_16x16x32_bf16 v[110:113], v[126:129], v[94:97], v[110:113]
    ds_read_b128 v[90:93], v7 offset:52224
    v_mfma_f32_16x16x32_bf16 v[114:117], v[130:133], v[94:97], v[114:117]
    v_rcp_f32 v142, v102
    buffer_load_dwordx4 v[126:129], v2, s[12:15], s30 offen offset:2048
    buffer_load_dwordx4 v[130:133], v2, s[12:15], s30 offen offset:3072
    v_mov_b64 v[30:31], 0
    v_mov_b64 v[32:33], 0
    v_mov_b64 v[34:35], 0
    v_mov_b64 v[36:37], 0
    v_mul_f32 v110, v110, v142
    v_mul_f32 v111, v111, v142
    v_mul_f32 v112, v112, v142
    v_mul_f32 v113, v113, v142
    v_mul_f32 v114, v114, v142
    v_mul_f32 v115, v115, v142
    v_mul_f32 v116, v116, v142
    v_mul_f32 v117, v117, v142
    v_cvt_pk_bf16_f32 v134, v110, v111
    v_cvt_pk_bf16_f32 v135, v112, v113
    v_cvt_pk_bf16_f32 v136, v114, v115
    v_cvt_pk_bf16_f32 v137, v116, v117
    s_mov_b64 exec, s[48:49]
    ds_write_b64 v10, v[134:135] offset:0
    ds_write_b64 v10, v[136:137] offset:32
    s_mov_b64 exec, -1
    v_mov_b64 v[38:39], 0
    v_mov_b64 v[40:41], 0
    v_mov_b64 v[42:43], 0
    v_mov_b64 v[44:45], 0
    v_mov_b64 v[46:47], 0
    v_mov_b64 v[48:49], 0
    v_mov_b64 v[50:51], 0
    v_mov_b64 v[52:53], 0
    v_mov_b64 v[54:55], 0
    v_mov_b64 v[56:57], 0
    v_mov_b64 v[58:59], 0
    v_mov_b64 v[60:61], 0
    s_add_u32 s52, s28, 32768
    s_add_u32 s29, s28, 4096
    s_add_u32 s96, s28, 36864
    s_waitcnt lgkmcnt(0)
    s_barrier
    ds_read_b128 v[94:97], v2 offset:0
    ds_read_b128 v[98:101], v2 offset:1024
    s_waitcnt lgkmcnt(1)
    v_smfmac_f32_16x16x64_bf16 v[30:33], v[94:97], v[62:69], v11
    v_smfmac_f32_16x16x64_bf16 v[34:37], v[94:97], v[70:77], v11
    ds_read_b128 v[62:65], v8 offset:0
    ds_read_b128 v[66:69], v8 offset:1024
    s_waitcnt lgkmcnt(2)
    v_smfmac_f32_16x16x64_bf16 v[30:33], v[98:101], v[78:85], v11
    ds_read_b128 v[70:73], v8 offset:2048
    v_smfmac_f32_16x16x64_bf16 v[34:37], v[98:101], v[86:93], v11
    ds_read_b128 v[74:77], v8 offset:3072
    v_smfmac_f32_16x16x64_bf16 v[38:41], v[94:97], v[176:183], v11
    v_smfmac_f32_16x16x64_bf16 v[42:45], v[94:97], v[184:191], v11
    v_add_f32 v30, v30, v32
    v_add_f32 v31, v31, v33
    v_smfmac_f32_16x16x64_bf16 v[38:41], v[98:101], v[192:199], v11
    v_add_f32 v34, v34, v36
    v_add_f32 v35, v35, v37
    v_smfmac_f32_16x16x64_bf16 v[42:45], v[98:101], v[200:207], v11
    v_cvt_pk_bf16_f32 v30, v30, v31
    v_cvt_pk_bf16_f32 v31, v34, v35
    v_smfmac_f32_16x16x64_bf16 v[46:49], v[94:97], v[208:215], v11
    buffer_store_dwordx2 v[30:31], v4, s[4:7], s28 offen sc1
    v_smfmac_f32_16x16x64_bf16 v[50:53], v[94:97], v[216:223], v11
    v_add_f32 v38, v38, v40
    v_add_f32 v39, v39, v41
    v_smfmac_f32_16x16x64_bf16 v[46:49], v[98:101], v[224:231], v11
    v_add_f32 v42, v42, v44
    v_add_f32 v43, v43, v45
    v_smfmac_f32_16x16x64_bf16 v[50:53], v[98:101], v[232:239], v11
    v_cvt_pk_bf16_f32 v38, v38, v39
    v_cvt_pk_bf16_f32 v39, v42, v43
    v_smfmac_f32_16x16x64_bf16 v[54:57], v[94:97], v[240:247], v11
    buffer_store_dwordx2 v[38:39], v4, s[4:7], s52 offen sc1
    v_smfmac_f32_16x16x64_bf16 v[58:61], v[94:97], v[248:255], v11
    v_add_f32 v46, v46, v48
    v_add_f32 v47, v47, v49
    s_waitcnt lgkmcnt(2)
    v_smfmac_f32_16x16x64_bf16 v[54:57], v[98:101], v[62:69], v11
    v_add_f32 v50, v50, v52
    v_add_f32 v51, v51, v53
    s_waitcnt lgkmcnt(0)
    v_smfmac_f32_16x16x64_bf16 v[58:61], v[98:101], v[70:77], v11
    v_cvt_pk_bf16_f32 v46, v46, v47
    v_cvt_pk_bf16_f32 v47, v50, v51
    buffer_store_dwordx2 v[46:47], v4, s[4:7], s29 offen sc1
    v_mov_b64 v[102:103], 0
    v_mov_b64 v[104:105], 0
    v_mov_b64 v[106:107], 0
    v_mov_b64 v[108:109], 0
    v_mov_b64 v[110:111], 0
    v_mov_b64 v[112:113], 0
    v_mov_b64 v[114:115], 0
    v_mov_b64 v[116:117], 0
    v_add_f32 v54, v54, v56
    v_add_f32 v55, v55, v57
    v_add_f32 v58, v58, v60
    v_add_f32 v59, v59, v61
    v_cvt_pk_bf16_f32 v54, v54, v55
    v_cvt_pk_bf16_f32 v55, v58, v59
    buffer_store_dwordx2 v[54:55], v4, s[4:7], s96 offen sc1
    v_mov_b64 v[94:95], 0
    v_mov_b64 v[96:97], 0
    v_mov_b64 v[98:99], 0
    v_mov_b64 v[100:101], 0
    ds_read_b128 v[62:65], v3 offset:0
    ds_read_b128 v[66:69], v3 offset:1024
    ds_read_b128 v[70:73], v3 offset:2048
    ds_read_b128 v[74:77], v3 offset:3072
    ds_read_b128 v[78:81], v3 offset:16384
    ds_read_b128 v[82:85], v3 offset:17408
    ds_read_b128 v[86:89], v3 offset:18432
    ds_read_b128 v[90:93], v3 offset:19456
    s_cmp_lt_u32 s25, 1
    s_cbranch_scc1 C_slow_noack
    s_waitcnt vmcnt(0)
C_slow_noack:
    s_mov_b32 s51, s27
    s_add_u32 s26, s26, 1
    s_cmp_ge_u32 s25, 2
    s_cbranch_scc1 C_slow_nored
    buffer_load_dwordx4 v[30:33], v5, s[4:7], s28 offen offset:0 sc1
    buffer_load_dwordx4 v[34:37], v5, s[4:7], s28 offen offset:1024 sc1
    buffer_load_dwordx4 v[38:41], v5, s[4:7], s28 offen offset:2048 sc1
    buffer_load_dwordx4 v[42:45], v5, s[4:7], s28 offen offset:3072 sc1
C_slow_r_poll:
    s_waitcnt vmcnt(3)
    v_mfma_f32_16x16x32_bf16 v[136:139], v[24:27], v[30:33], 0
    s_waitcnt vmcnt(2)
    v_mfma_f32_16x16x32_bf16 v[136:139], v[24:27], v[34:37], v[136:139]
    s_waitcnt vmcnt(1)
    v_mfma_f32_16x16x32_bf16 v[136:139], v[24:27], v[38:41], v[136:139]
    s_waitcnt vmcnt(0)
    v_mfma_f32_16x16x32_bf16 v[136:139], v[24:27], v[42:45], v[136:139]
    s_nop 7
    v_cmp_u_f32 vcc, v136, v137
    v_cmp_u_f32 s[60:61], v138, v139
    v_add_f32_dpp v136, v136, v136 row_ror:8 row_mask:0xf bank_mask:0xf
    v_add_f32_dpp v137, v137, v137 row_ror:8 row_mask:0xf bank_mask:0xf
    v_add_f32_dpp v138, v138, v138 row_ror:8 row_mask:0xf bank_mask:0xf
    v_add_f32_dpp v139, v139, v139 row_ror:8 row_mask:0xf bank_mask:0xf
    s_or_b64 vcc, vcc, s[60:61]
    s_nop 0
    s_cbranch_scc0 C_slow_r_ok
    v_max3_u32 v134, v30, v31, v32
    v_max_u32 v134, v134, v33
    v_cmp_eq_u32 s[60:61], -1, v134
    v_max3_u32 v134, v34, v35, v36
    v_max_u32 v134, v134, v37
    v_cmp_eq_u32 s[62:63], -1, v134
    v_max3_u32 v134, v38, v39, v40
    v_max_u32 v134, v134, v41
    v_cmp_eq_u32 s[56:57], -1, v134
    v_max3_u32 v134, v42, v43, v44
    v_max_u32 v134, v134, v45
    v_cmp_eq_u32 s[36:37], -1, v134
    s_or_b64 vcc, s[60:61], s[62:63]
    s_or_b64 vcc, vcc, s[56:57]
    s_or_b64 vcc, vcc, s[36:37]
    s_nop 1
    s_cbranch_scc0 C_slow_r_ok
    s_cmp_eq_u32 s33, 0
    s_cbranch_scc1 C_slow_r_ok
    s_sub_u32 s33, s33, 1
    s_mov_b64 exec, s[60:61]
    buffer_load_dwordx4 v[30:33], v5, s[4:7], s28 offen offset:0 sc1
    s_mov_b64 exec, s[62:63]
    buffer_load_dwordx4 v[34:37], v5, s[4:7], s28 offen offset:1024 sc1
    s_mov_b64 exec, s[56:57]
    buffer_load_dwordx4 v[38:41], v5, s[4:7], s28 offen offset:2048 sc1
    s_mov_b64 exec, s[36:37]
    buffer_load_dwordx4 v[42:45], v5, s[4:7], s28 offen offset:3072 sc1
    s_mov_b64 exec, -1
    s_branch C_slow_r_poll
C_slow_r_ok:
    v_cvt_pk_bf16_f32 v136, v136, v138
    v_cvt_pk_bf16_f32 v137, v137, v139
    v_cndmask_b32 v136, v136, v137, s[44:45]
    v_min_u32 v136, -2, v136
    s_mov_b32 exec_hi, 0
    buffer_store_dword v136, v6, s[8:11], s51 offen sc1
    s_mov_b32 exec_hi, -1
C_slow_nored:
    s_barrier
    s_add_u32 s27, s27, 8192
    s_cmp_eq_u32 s27, 24576
    s_cselect_b32 s27, 0, s27
    s_add_u32 s34, s27, 8192
    s_cmp_eq_u32 s34, 24576
    s_cselect_b32 s34, 0, s34
    s_lshl_b32 s38, s24, 8
    s_add_u32 s38, s38, s34
    s_add_u32 s53, s59, s28
    s_add_u32 s28, s28, 262144
    s_cmp_eq_u32 s28, 786432
    s_cselect_b32 s28, 0, s28
    s_add_u32 s30, s30, 524288
    s_add_u32 s31, s31, 524288
    s_add_u32 s32, s32, 262144
    v_mov_b32 v138, -1
    v_mov_b32 v139, -1
    v_mov_b32 v140, -1
    v_mov_b32 v141, -1
    s_sleep 2
    buffer_load_dwordx4 v[30:33], v1, s[8:11], s51 offen sc1
    buffer_load_dwordx4 v[34:37], v1, s[8:11], s51 offen offset:1024 sc1
C_slow_g_poll:
    s_waitcnt vmcnt(1)
    v_max3_u32 v134, v30, v31, v32
    v_max_u32 v134, v134, v33
    v_cmp_eq_u32 s[60:61], -1, v134
    s_waitcnt vmcnt(0)
    v_max3_u32 v135, v34, v35, v36
    v_max_u32 v135, v135, v37
    v_cmp_eq_u32 s[62:63], -1, v135
    ds_write_b128 v1, v[30:33] offset:0
    ds_write_b128 v1, v[34:37] offset:1024
    s_or_b64 vcc, s[60:61], s[62:63]
    s_nop 1
    s_cbranch_scc0 C_slow_g_ok
    s_cmp_eq_u32 s33, 0
    s_cbranch_scc1 C_slow_g_ok
    s_sub_u32 s33, s33, 1
    s_mov_b64 exec, s[60:61]
    buffer_load_dwordx4 v[30:33], v1, s[8:11], s51 offen sc1
    s_mov_b64 exec, s[62:63]
    buffer_load_dwordx4 v[34:37], v1, s[8:11], s51 offen offset:1024 sc1
    s_mov_b64 exec, -1
    s_branch C_slow_g_poll
C_slow_g_ok:
    s_waitcnt vmcnt(0) lgkmcnt(0)
    s_barrier
    s_branch C_slow_step
C_slow_last:
    s_waitcnt vmcnt(0) lgkmcnt(0)
    s_barrier
    s_cmp_lg_u32 s25, 3
    s_cbranch_scc1 C_slow_end
    v_mov_b32 v134, 64
    s_lshl_b32 s34, s24, 7
    s_add_u32 s34, s34, 1024
    v_mov_b32 v135, 0
    s_mov_b64 exec, 1
    buffer_store_dword v134, v135, s[40:43], s34 offen sc1
    s_mov_b64 exec, -1
    s_waitcnt vmcnt(0)
C_slow_end:
C_exit:
    s_branch L_end
L_worker:
    s_sub_u32 s24, s90, 32
    s_load_dwordx2 s[44:45], s[0:1], 104
    v_lshrrev_b32 v1, 6, v0
    s_nop 0
    v_readfirstlane_b32 s25, v1
    s_waitcnt lgkmcnt(0)
    s_add_u32 s8, s44, 4194304
    s_addc_u32 s9, s45, 0
    s_mov_b32 s10, 2097152
    s_mov_b32 s11, 0x20000
    s_add_u32 s12, s44, 8388608
    s_addc_u32 s13, s45, 0
    s_mov_b32 s14, 33554432
    s_mov_b32 s15, 0x20000
    s_mov_b32 s40, s44
    s_mov_b32 s41, s45
    s_mov_b32 s42, 65536
    s_mov_b32 s43, 0x20000
    v_and_b32 v3, 63, v0
    v_and_b32 v4, 15, v3
    v_lshrrev_b32 v5, 4, v3
    v_lshlrev_b32 v1, 4, v3
    v_mov_b32 v7, 0
    s_lshl_b32 s30, s25, 15
    s_add_u32 s30, s30, 0
    v_bfe_u32 v8, v3, 2, 2
    v_lshl_add_u32 v8, v5, 2, v8
    v_and_b32 v9, 3, v3
    v_lshlrev_b32 v9, 3, v9
    v_lshl_add_u32 v2, v8, 6, v9
    v_add_u32 v2, s30, v2
    s_mov_b32 s33, 400000
    s_cmp_ge_u32 s24, 128
    s_cbranch_scc1 LN_done
    s_load_dwordx2 s[46:47], s[0:1], 0
    s_waitcnt lgkmcnt(0)
    s_mov_b32 s16, s46
    s_mov_b32 s17, s47
    s_mov_b32 s18, 2097152
    s_mov_b32 s19, 0x20000
    v_lshlrev_b32 v8, 10, v4
    v_lshl_add_u32 v8, v5, 3, v8
    s_lshl_b32 s34, s24, 14
    s_lshl_b32 s35, s25, 8
    s_add_u32 s34, s34, s35
    buffer_load_dwordx2 v[16:17], v8, s[16:19], s34 offen offset:0
    buffer_load_dwordx2 v[18:19], v8, s[16:19], s34 offen offset:32
    buffer_load_dwordx2 v[20:21], v8, s[16:19], s34 offen offset:64
    buffer_load_dwordx2 v[22:23], v8, s[16:19], s34 offen offset:96
    buffer_load_dwordx2 v[24:25], v8, s[16:19], s34 offen offset:128
    buffer_load_dwordx2 v[26:27], v8, s[16:19], s34 offen offset:160
    buffer_load_dwordx2 v[28:29], v8, s[16:19], s34 offen offset:192
    buffer_load_dwordx2 v[30:31], v8, s[16:19], s34 offen offset:224
    s_waitcnt vmcnt(7)
    v_lshlrev_b32 v32, 16, v16
    v_and_b32 v33, 0xffff0000, v16
    v_lshlrev_b32 v34, 16, v17
    v_and_b32 v35, 0xffff0000, v17
    s_waitcnt vmcnt(6)
    v_lshlrev_b32 v36, 16, v18
    v_and_b32 v37, 0xffff0000, v18
    v_lshlrev_b32 v38, 16, v19
    v_and_b32 v39, 0xffff0000, v19
    s_waitcnt vmcnt(5)
    v_lshlrev_b32 v40, 16, v20
    v_and_b32 v41, 0xffff0000, v20
    v_lshlrev_b32 v42, 16, v21
    v_and_b32 v43, 0xffff0000, v21
    s_waitcnt vmcnt(4)
    v_lshlrev_b32 v44, 16, v22
    v_and_b32 v45, 0xffff0000, v22
    v_lshlrev_b32 v46, 16, v23
    v_and_b32 v47, 0xffff0000, v23
    s_waitcnt vmcnt(3)
    v_lshlrev_b32 v48, 16, v24
    v_and_b32 v49, 0xffff0000, v24
    v_lshlrev_b32 v50, 16, v25
    v_and_b32 v51, 0xffff0000, v25
    s_waitcnt vmcnt(2)
    v_lshlrev_b32 v52, 16, v26
    v_and_b32 v53, 0xffff0000, v26
    v_lshlrev_b32 v54, 16, v27
    v_and_b32 v55, 0xffff0000, v27
    s_waitcnt vmcnt(1)
    v_lshlrev_b32 v56, 16, v28
    v_and_b32 v57, 0xffff0000, v28
    v_lshlrev_b32 v58, 16, v29
    v_and_b32 v59, 0xffff0000, v29
    s_waitcnt vmcnt(0)
    v_lshlrev_b32 v60, 16, v30
    v_and_b32 v61, 0xffff0000, v30
    v_lshlrev_b32 v62, 16, v31
    v_and_b32 v63, 0xffff0000, v31
    v_add_f32 v10, v32, v33
    v_add_f32 v10, v10, v34
    v_add_f32 v10, v10, v35
    v_add_f32 v10, v10, v36
    v_add_f32 v10, v10, v37
    v_add_f32 v10, v10, v38
    v_add_f32 v10, v10, v39
    v_add_f32 v11, v40, v41
    v_add_f32 v11, v11, v42
    v_add_f32 v11, v11, v43
    v_add_f32 v11, v11, v44
    v_add_f32 v11, v11, v45
    v_add_f32 v11, v11, v46
    v_add_f32 v11, v11, v47
    v_add_f32 v12, v48, v49
    v_add_f32 v12, v12, v50
    v_add_f32 v12, v12, v51
    v_add_f32 v12, v12, v52
    v_add_f32 v12, v12, v53
    v_add_f32 v12, v12, v54
    v_add_f32 v12, v12, v55
    v_add_f32 v13, v56, v57
    v_add_f32 v13, v13, v58
    v_add_f32 v13, v13, v59
    v_add_f32 v13, v13, v60
    v_add_f32 v13, v13, v61
    v_add_f32 v13, v13, v62
    v_add_f32 v13, v13, v63
    v_add_f32 v10, v10, v11
    v_add_f32 v12, v12, v13
    v_add_f32 v10, v10, v12
    v_mov_b32 v11, v10
    s_nop 1
    v_permlane16_swap_b32 v11, v10
    v_add_f32 v10, v10, v11
    v_mov_b32 v11, v10
    s_nop 1
    v_permlane32_swap_b32 v11, v10
    v_add_f32 v10, v10, v11
    s_lshl_b32 s35, s25, 8
    s_add_u32 s35, s35, 131072
    v_lshlrev_b32 v12, 2, v3
    v_add_u32 v13, s35, v12
    v_add_u32 v12, 131072, v12
    ds_write_b32 v13, v10
    s_waitcnt lgkmcnt(0)
    s_barrier
    ds_read_b32 v64, v12 offset:0
    ds_read_b32 v65, v12 offset:256
    ds_read_b32 v66, v12 offset:512
    ds_read_b32 v67, v12 offset:768
    s_waitcnt lgkmcnt(2)
    v_add_f32 v64, v64, v65
    s_waitcnt lgkmcnt(0)
    v_add_f32 v66, v66, v67
    v_add_f32 v10, v64, v66
    v_mul_f32 v10, 0x3b000000, v10
    v_sub_f32 v32, v32, v10
    v_sub_f32 v33, v33, v10
    v_sub_f32 v34, v34, v10
    v_sub_f32 v35, v35, v10
    v_sub_f32 v36, v36, v10
    v_sub_f32 v37, v37, v10
    v_sub_f32 v38, v38, v10
    v_sub_f32 v39, v39, v10
    v_sub_f32 v40, v40, v10
    v_sub_f32 v41, v41, v10
    v_sub_f32 v42, v42, v10
    v_sub_f32 v43, v43, v10
    v_sub_f32 v44, v44, v10
    v_sub_f32 v45, v45, v10
    v_sub_f32 v46, v46, v10
    v_sub_f32 v47, v47, v10
    v_sub_f32 v48, v48, v10
    v_sub_f32 v49, v49, v10
    v_sub_f32 v50, v50, v10
    v_sub_f32 v51, v51, v10
    v_sub_f32 v52, v52, v10
    v_sub_f32 v53, v53, v10
    v_sub_f32 v54, v54, v10
    v_sub_f32 v55, v55, v10
    v_sub_f32 v56, v56, v10
    v_sub_f32 v57, v57, v10
    v_sub_f32 v58, v58, v10
    v_sub_f32 v59, v59, v10
    v_sub_f32 v60, v60, v10
    v_sub_f32 v61, v61, v10
    v_sub_f32 v62, v62, v10
    v_sub_f32 v63, v63, v10
    v_mul_f32 v64, v32, v32
    v_fmac_f32 v64, v33, v33
    v_fmac_f32 v64, v34, v34
    v_fmac_f32 v64, v35, v35
    v_fmac_f32 v64, v36, v36
    v_fmac_f32 v64, v37, v37
    v_fmac_f32 v64, v38, v38
    v_fmac_f32 v64, v39, v39
    v_mul_f32 v65, v40, v40
    v_fmac_f32 v65, v41, v41
    v_fmac_f32 v65, v42, v42
    v_fmac_f32 v65, v43, v43
    v_fmac_f32 v65, v44, v44
    v_fmac_f32 v65, v45, v45
    v_fmac_f32 v65, v46, v46
    v_fmac_f32 v65, v47, v47
    v_mul_f32 v66, v48, v48
    v_fmac_f32 v66, v49, v49
    v_fmac_f32 v66, v50, v50
    v_fmac_f32 v66, v51, v51
    v_fmac_f32 v66, v52, v52
    v_fmac_f32 v66, v53, v53
    v_fmac_f32 v66, v54, v54
    v_fmac_f32 v66, v55, v55
    v_mul_f32 v67, v56, v56
    v_fmac_f32 v67, v57, v57
    v_fmac_f32 v67, v58, v58
    v_fmac_f32 v67, v59, v59
    v_fmac_f32 v67, v60, v60
    v_fmac_f32 v67, v61, v61
    v_fmac_f32 v67, v62, v62
    v_fmac_f32 v67, v63, v63
    v_add_f32 v64, v64, v65
    v_add_f32 v66, v66, v67
    v_add_f32 v10, v64, v66
    v_mov_b32 v11, v10
    s_nop 1
    v_permlane16_swap_b32 v11, v10
    v_add_f32 v10, v10, v11
    v_mov_b32 v11, v10
    s_nop 1
    v_permlane32_swap_b32 v11, v10
    v_add_f32 v10, v10, v11
    ds_write_b32 v13, v10 offset:1024
    s_waitcnt lgkmcnt(0)
    s_barrier
    ds_read_b32 v64, v12 offset:1024
    ds_read_b32 v65, v12 offset:1280
    ds_read_b32 v66, v12 offset:1536
    ds_read_b32 v67, v12 offset:1792
    s_waitcnt lgkmcnt(2)
    v_add_f32 v64, v64, v65
    s_waitcnt lgkmcnt(0)
    v_add_f32 v66, v66, v67
    v_add_f32 v10, v64, v66
    v_mov_b32 v11, 0x3727c5ac
    v_fmac_f32 v11, 0x3b000000, v10
    v_rsq_f32 v11, v11
    s_nop 0
    v_mul_f32 v32, v32, v11
    v_mul_f32 v33, v33, v11
    v_mul_f32 v34, v34, v11
    v_mul_f32 v35, v35, v11
    v_mul_f32 v36, v36, v11
    v_mul_f32 v37, v37, v11
    v_mul_f32 v38, v38, v11
    v_mul_f32 v39, v39, v11
    v_mul_f32 v40, v40, v11
    v_mul_f32 v41, v41, v11
    v_mul_f32 v42, v42, v11
    v_mul_f32 v43, v43, v11
    v_mul_f32 v44, v44, v11
    v_mul_f32 v45, v45, v11
    v_mul_f32 v46, v46, v11
    v_mul_f32 v47, v47, v11
    v_mul_f32 v48, v48, v11
    v_mul_f32 v49, v49, v11
    v_mul_f32 v50, v50, v11
    v_mul_f32 v51, v51, v11
    v_mul_f32 v52, v52, v11
    v_mul_f32 v53, v53, v11
    v_mul_f32 v54, v54, v11
    v_mul_f32 v55, v55, v11
    v_mul_f32 v56, v56, v11
    v_mul_f32 v57, v57, v11
    v_mul_f32 v58, v58, v11
    v_mul_f32 v59, v59, v11
    v_mul_f32 v60, v60, v11
    v_mul_f32 v61, v61, v11
    v_mul_f32 v62, v62, v11
    v_mul_f32 v63, v63, v11
    v_cvt_pk_bf16_f32 v16, v32, v33
    v_cvt_pk_bf16_f32 v17, v34, v35
    v_cvt_pk_bf16_f32 v18, v36, v37
    v_cvt_pk_bf16_f32 v19, v38, v39
    v_cvt_pk_bf16_f32 v20, v40, v41
    v_cvt_pk_bf16_f32 v21, v42, v43
    v_cvt_pk_bf16_f32 v22, v44, v45
    v_cvt_pk_bf16_f32 v23, v46, v47
    v_cvt_pk_bf16_f32 v24, v48, v49
    v_cvt_pk_bf16_f32 v25, v50, v51
    v_cvt_pk_bf16_f32 v26, v52, v53
    v_cvt_pk_bf16_f32 v27, v54, v55
    v_cvt_pk_bf16_f32 v28, v56, v57
    v_cvt_pk_bf16_f32 v29, v58, v59
    v_cvt_pk_bf16_f32 v30, v60, v61
    v_cvt_pk_bf16_f32 v31, v62, v63
    s_lshl_b32 s34, s24, 14
    s_lshl_b32 s35, s25, 12
    s_add_u32 s34, s34, s35
    buffer_store_dwordx4 v[16:19], v1, s[8:11], s34 offen offset:0 sc1
    buffer_store_dwordx4 v[20:23], v1, s[8:11], s34 offen offset:1024 sc1
    buffer_store_dwordx4 v[24:27], v1, s[8:11], s34 offen offset:2048 sc1
    buffer_store_dwordx4 v[28:31], v1, s[8:11], s34 offen offset:3072 sc1
    s_waitcnt vmcnt(0)
    s_barrier
    s_cmp_lg_u32 s25, 0
    s_cbranch_scc1 LN_ln_noarr
    v_mov_b32 v8, 1
    s_mov_b32 s34, 128
    s_mov_b64 exec, 1
    buffer_atomic_add v8, v7, s[40:43], s34 offen
    s_mov_b64 exec, -1
LN_ln_noarr:
LN_done:
    s_mul_i32 s28, s24, 9363
    s_lshr_b32 s28, s28, 16
    s_mul_i32 s34, s28, 7
    s_sub_u32 s29, s24, s34
    s_lshl_b32 s31, s28, 8
    s_load_dwordx2 s[46:47], s[0:1], 24
    s_waitcnt lgkmcnt(0)
    s_mov_b32 s4, s46
    s_mov_b32 s5, s47
    s_mov_b32 s6, 4194304
    s_mov_b32 s7, 0x20000
    s_load_dwordx2 s[46:47], s[0:1], 32
    s_waitcnt lgkmcnt(0)
    s_mov_b32 s20, s46
    s_mov_b32 s21, s47
    s_mov_b32 s22, 4194304
    s_mov_b32 s23, 0x20000
    v_lshrrev_b32 v14, 4, v3
    s_mov_b32 s34, 8192
    v_mul_lo_u32 v10, v14, s34
    v_lshlrev_b32 v14, 1, v14
    v_xor_b32 v14, v14, v4
    v_lshl_add_u32 v10, v14, 4, v10
    v_xor_b32 v11, 0x80, v10
    v_bfe_u32 v14, v3, 2, 2
    v_lshl_add_u32 v15, v5, 2, v14
    v_lshlrev_b32 v12, 8, v15
    v_lshlrev_b32 v14, 1, v14
    v_and_b32 v15, 1, v5
    v_lshl_add_u32 v14, v15, 3, v14
    v_bfe_u32 v15, v3, 1, 1
    v_xor_b32 v14, v14, v15
    v_lshl_add_u32 v12, v14, 4, v12
    v_and_b32 v15, 1, v3
    v_lshl_add_u32 v12, v15, 3, v12
    s_mul_i32 s38, s25, 131072
    s_lshl_b32 s37, s25, 12
    s_waitcnt vmcnt(0) lgkmcnt(0)
    s_barrier
    s_add_u32 s34, s31, 0
    s_add_u32 s34, s34, s38
    s_add_u32 m0, s37, 0
    s_nop 0
    buffer_load_dwordx4 v10, s[4:7], s34 offen lds
    s_add_u32 s34, s31, 32768
    s_add_u32 s34, s34, s38
    s_add_u32 m0, s37, 1024
    s_nop 0
    buffer_load_dwordx4 v11, s[4:7], s34 offen lds
    s_add_u32 s34, s31, 65536
    s_add_u32 s34, s34, s38
    s_add_u32 m0, s37, 2048
    s_nop 0
    buffer_load_dwordx4 v10, s[4:7], s34 offen lds
    s_add_u32 s34, s31, 98304
    s_add_u32 s34, s34, s38
    s_add_u32 m0, s37, 3072
    s_nop 0
    buffer_load_dwordx4 v11, s[4:7], s34 offen lds
    s_add_u32 s34, s31, 524288
    s_add_u32 s34, s34, s38
    s_add_u32 m0, s37, 16384
    s_nop 0
    buffer_load_dwordx4 v10, s[4:7], s34 offen lds
    s_add_u32 s34, s31, 557056
    s_add_u32 s34, s34, s38
    s_add_u32 m0, s37, 17408
    s_nop 0
    buffer_load_dwordx4 v11, s[4:7], s34 offen lds
    s_add_u32 s34, s31, 589824
    s_add_u32 s34, s34, s38
    s_add_u32 m0, s37, 18432
    s_nop 0
    buffer_load_dwordx4 v10, s[4:7], s34 offen lds
    s_add_u32 s34, s31, 622592
    s_add_u32 s34, s34, s38
    s_add_u32 m0, s37, 19456
    s_nop 0
    buffer_load_dwordx4 v11, s[4:7], s34 offen lds
    s_add_u32 s34, s31, 1048576
    s_add_u32 s34, s34, s38
    s_add_u32 m0, s37, 32768
    s_nop 0
    buffer_load_dwordx4 v10, s[4:7], s34 offen lds
    s_add_u32 s34, s31, 1081344
    s_add_u32 s34, s34, s38
    s_add_u32 m0, s37, 33792
    s_nop 0
    buffer_load_dwordx4 v11, s[4:7], s34 offen lds
    s_add_u32 s34, s31, 1114112
    s_add_u32 s34, s34, s38
    s_add_u32 m0, s37, 34816
    s_nop 0
    buffer_load_dwordx4 v10, s[4:7], s34 offen lds
    s_add_u32 s34, s31, 1146880
    s_add_u32 s34, s34, s38
    s_add_u32 m0, s37, 35840
    s_nop 0
    buffer_load_dwordx4 v11, s[4:7], s34 offen lds
    s_add_u32 s34, s31, 1572864
    s_add_u32 s34, s34, s38
    s_add_u32 m0, s37, 49152
    s_nop 0
    buffer_load_dwordx4 v10, s[4:7], s34 offen lds
    s_add_u32 s34, s31, 1605632
    s_add_u32 s34, s34, s38
    s_add_u32 m0, s37, 50176
    s_nop 0
    buffer_load_dwordx4 v11, s[4:7], s34 offen lds
    s_add_u32 s34, s31, 1638400
    s_add_u32 s34, s34, s38
    s_add_u32 m0, s37, 51200
    s_nop 0
    buffer_load_dwordx4 v10, s[4:7], s34 offen lds
    s_add_u32 s34, s31, 1671168
    s_add_u32 s34, s34, s38
    s_add_u32 m0, s37, 52224
    s_nop 0
    buffer_load_dwordx4 v11, s[4:7], s34 offen lds
    s_add_u32 s34, s31, 2097152
    s_add_u32 s34, s34, s38
    s_add_u32 m0, s37, 65536
    s_nop 0
    buffer_load_dwordx4 v10, s[4:7], s34 offen lds
    s_add_u32 s34, s31, 2129920
    s_add_u32 s34, s34, s38
    s_add_u32 m0, s37, 66560
    s_nop 0
    buffer_load_dwordx4 v11, s[4:7], s34 offen lds
    s_add_u32 s34, s31, 2162688
    s_add_u32 s34, s34, s38
    s_add_u32 m0, s37, 67584
    s_nop 0
    buffer_load_dwordx4 v10, s[4:7], s34 offen lds
    s_add_u32 s34, s31, 2195456
    s_add_u32 s34, s34, s38
    s_add_u32 m0, s37, 68608
    s_nop 0
    buffer_load_dwordx4 v11, s[4:7], s34 offen lds
    s_add_u32 s34, s31, 2621440
    s_add_u32 s34, s34, s38
    s_add_u32 m0, s37, 81920
    s_nop 0
    buffer_load_dwordx4 v10, s[4:7], s34 offen lds
    s_add_u32 s34, s31, 2654208
    s_add_u32 s34, s34, s38
    s_add_u32 m0, s37, 82944
    s_nop 0
    buffer_load_dwordx4 v11, s[4:7], s34 offen lds
    s_add_u32 s34, s31, 2686976
    s_add_u32 s34, s34, s38
    s_add_u32 m0, s37, 83968
    s_nop 0
    buffer_load_dwordx4 v10, s[4:7], s34 offen lds
    s_add_u32 s34, s31, 2719744
    s_add_u32 s34, s34, s38
    s_add_u32 m0, s37, 84992
    s_nop 0
    buffer_load_dwordx4 v11, s[4:7], s34 offen lds
    s_add_u32 s34, s31, 3145728
    s_add_u32 s34, s34, s38
    s_add_u32 m0, s37, 98304
    s_nop 0
    buffer_load_dwordx4 v10, s[4:7], s34 offen lds
    s_add_u32 s34, s31, 3178496
    s_add_u32 s34, s34, s38
    s_add_u32 m0, s37, 99328
    s_nop 0
    buffer_load_dwordx4 v11, s[4:7], s34 offen lds
    s_add_u32 s34, s31, 3211264
    s_add_u32 s34, s34, s38
    s_add_u32 m0, s37, 100352
    s_nop 0
    buffer_load_dwordx4 v10, s[4:7], s34 offen lds
    s_add_u32 s34, s31, 3244032
    s_add_u32 s34, s34, s38
    s_add_u32 m0, s37, 101376
    s_nop 0
    buffer_load_dwordx4 v11, s[4:7], s34 offen lds
    s_waitcnt vmcnt(24)
    s_barrier
    s_add_u32 s34, s31, 3670016
    s_add_u32 s34, s34, s38
    s_add_u32 m0, s37, 114688
    s_nop 0
    buffer_load_dwordx4 v10, s[4:7], s34 offen lds
    s_add_u32 s34, s31, 3702784
    s_add_u32 s34, s34, s38
    s_add_u32 m0, s37, 115712
    s_nop 0
    buffer_load_dwordx4 v11, s[4:7], s34 offen lds
    s_add_u32 s34, s31, 3735552
    s_add_u32 s34, s34, s38
    s_add_u32 m0, s37, 116736
    s_nop 0
    buffer_load_dwordx4 v10, s[4:7], s34 offen lds
    s_add_u32 s34, s31, 3768320
    s_add_u32 s34, s34, s38
    s_add_u32 m0, s37, 117760
    s_nop 0
    buffer_load_dwordx4 v11, s[4:7], s34 offen lds
    s_lshl_b32 s34, s25, 6
    s_add_u32 s34, s34, 0
    v_xor_b32 v13, s34, v12
    v_add_u32 v13, 0, v13
    ds_read_b64_tr_b16 a[0:1], v13 offset:0
    ds_read_b64_tr_b16 a[2:3], v13 offset:4096
    ds_read_b64_tr_b16 a[8:9], v13 offset:8192
    ds_read_b64_tr_b16 a[10:11], v13 offset:12288
    s_lshl_b32 s34, s25, 6
    s_add_u32 s34, s34, 32
    v_xor_b32 v13, s34, v12
    v_add_u32 v13, 0, v13
    ds_read_b64_tr_b16 a[4:5], v13 offset:0
    ds_read_b64_tr_b16 a[6:7], v13 offset:4096
    ds_read_b64_tr_b16 a[12:13], v13 offset:8192
    ds_read_b64_tr_b16 a[14:15], v13 offset:12288
    s_waitcnt lgkmcnt(0)
    s_waitcnt vmcnt(24)
    s_barrier
    s_add_u32 s34, s31, 0
    s_add_u32 s34, s34, s38
    s_add_u32 m0, s37, 0
    s_nop 0
    buffer_load_dwordx4 v10, s[20:23], s34 offen lds
    s_add_u32 s34, s31, 32768
    s_add_u32 s34, s34, s38
    s_add_u32 m0, s37, 1024
    s_nop 0
    buffer_load_dwordx4 v11, s[20:23], s34 offen lds
    s_add_u32 s34, s31, 65536
    s_add_u32 s34, s34, s38
    s_add_u32 m0, s37, 2048
    s_nop 0
    buffer_load_dwordx4 v10, s[20:23], s34 offen lds
    s_add_u32 s34, s31, 98304
    s_add_u32 s34, s34, s38
    s_add_u32 m0, s37, 3072
    s_nop 0
    buffer_load_dwordx4 v11, s[20:23], s34 offen lds
    s_lshl_b32 s34, s25, 6
    s_add_u32 s34, s34, 0
    v_xor_b32 v13, s34, v12
    v_add_u32 v13, 16384, v13
    ds_read_b64_tr_b16 a[16:17], v13 offset:0
    ds_read_b64_tr_b16 a[18:19], v13 offset:4096
    ds_read_b64_tr_b16 a[24:25], v13 offset:8192
    ds_read_b64_tr_b16 a[26:27], v13 offset:12288
    s_lshl_b32 s34, s25, 6
    s_add_u32 s34, s34, 32
    v_xor_b32 v13, s34, v12
    v_add_u32 v13, 16384, v13
    ds_read_b64_tr_b16 a[20:21], v13 offset:0
    ds_read_b64_tr_b16 a[22:23], v13 offset:4096
    ds_read_b64_tr_b16 a[28:29], v13 offset:8192
    ds_read_b64_tr_b16 a[30:31], v13 offset:12288
    s_waitcnt lgkmcnt(0)
    s_waitcnt vmcnt(24)
    s_barrier
    s_add_u32 s34, s31, 524288
    s_add_u32 s34, s34, s38
    s_add_u32 m0, s37, 16384
    s_nop 0
    buffer_load_dwordx4 v10, s[20:23], s34 offen lds
    s_add_u32 s34, s31, 557056
    s_add_u32 s34, s34, s38
    s_add_u32 m0, s37, 17408
    s_nop 0
    buffer_load_dwordx4 v11, s[20:23], s34 offen lds
    s_add_u32 s34, s31, 589824
    s_add_u32 s34, s34, s38
    s_add_u32 m0, s37, 18432
    s_nop 0
    buffer_load_dwordx4 v10, s[20:23], s34 offen lds
    s_add_u32 s34, s31, 622592
    s_add_u32 s34, s34, s38
    s_add_u32 m0, s37, 19456
    s_nop 0
    buffer_load_dwordx4 v11, s[20:23], s34 offen lds
    s_lshl_b32 s34, s25, 6
    s_add_u32 s34, s34, 0
    v_xor_b32 v13, s34, v12
    v_add_u32 v13, 32768, v13
    ds_read_b64_tr_b16 a[32:33], v13 offset:0
    ds_read_b64_tr_b16 a[34:35], v13 offset:4096
    ds_read_b64_tr_b16 a[40:41], v13 offset:8192
    ds_read_b64_tr_b16 a[42:43], v13 offset:12288
    s_lshl_b32 s34, s25, 6
    s_add_u32 s34, s34, 32
    v_xor_b32 v13, s34, v12
    v_add_u32 v13, 32768, v13
    ds_read_b64_tr_b16 a[36:37], v13 offset:0
    ds_read_b64_tr_b16 a[38:39], v13 offset:4096
    ds_read_b64_tr_b16 a[44:45], v13 offset:8192
    ds_read_b64_tr_b16 a[46:47], v13 offset:12288
    s_waitcnt lgkmcnt(0)
    s_waitcnt vmcnt(24)
    s_barrier
    s_add_u32 s34, s31, 1048576
    s_add_u32 s34, s34, s38
    s_add_u32 m0, s37, 32768
    s_nop 0
    buffer_load_dwordx4 v10, s[20:23], s34 offen lds
    s_add_u32 s34, s31, 1081344
    s_add_u32 s34, s34, s38
    s_add_u32 m0, s37, 33792
    s_nop 0
    buffer_load_dwordx4 v11, s[20:23], s34 offen lds
    s_add_u32 s34, s31, 1114112
    s_add_u32 s34, s34, s38
    s_add_u32 m0, s37, 34816
    s_nop 0
    buffer_load_dwordx4 v10, s[20:23], s34 offen lds
    s_add_u32 s34, s31, 1146880
    s_add_u32 s34, s34, s38
    s_add_u32 m0, s37, 35840
    s_nop 0
    buffer_load_dwordx4 v11, s[20:23], s34 offen lds
    s_lshl_b32 s34, s25, 6
    s_add_u32 s34, s34, 0
    v_xor_b32 v13, s34, v12
    v_add_u32 v13, 49152, v13
    ds_read_b64_tr_b16 a[48:49], v13 offset:0
    ds_read_b64_tr_b16 a[50:51], v13 offset:4096
    ds_read_b64_tr_b16 a[56:57], v13 offset:8192
    ds_read_b64_tr_b16 a[58:59], v13 offset:12288
    s_lshl_b32 s34, s25, 6
    s_add_u32 s34, s34, 32
    v_xor_b32 v13, s34, v12
    v_add_u32 v13, 49152, v13
    ds_read_b64_tr_b16 a[52:53], v13 offset:0
    ds_read_b64_tr_b16 a[54:55], v13 offset:4096
    ds_read_b64_tr_b16 a[60:61], v13 offset:8192
    ds_read_b64_tr_b16 a[62:63], v13 offset:12288
    s_waitcnt lgkmcnt(0)
    s_waitcnt vmcnt(24)
    s_barrier
    s_add_u32 s34, s31, 1572864
    s_add_u32 s34, s34, s38
    s_add_u32 m0, s37, 49152
    s_nop 0
    buffer_load_dwordx4 v10, s[20:23], s34 offen lds
    s_add_u32 s34, s31, 1605632
    s_add_u32 s34, s34, s38
    s_add_u32 m0, s37, 50176
    s_nop 0
    buffer_load_dwordx4 v11, s[20:23], s34 offen lds
    s_add_u32 s34, s31, 1638400
    s_add_u32 s34, s34, s38
    s_add_u32 m0, s37, 51200
    s_nop 0
    buffer_load_dwordx4 v10, s[20:23], s34 offen lds
    s_add_u32 s34, s31, 1671168
    s_add_u32 s34, s34, s38
    s_add_u32 m0, s37, 52224
    s_nop 0
    buffer_load_dwordx4 v11, s[20:23], s34 offen lds
    s_lshl_b32 s34, s25, 6
    s_add_u32 s34, s34, 0
    v_xor_b32 v13, s34, v12
    v_add_u32 v13, 65536, v13
    ds_read_b64_tr_b16 a[64:65], v13 offset:0
    ds_read_b64_tr_b16 a[66:67], v13 offset:4096
    ds_read_b64_tr_b16 a[72:73], v13 offset:8192
    ds_read_b64_tr_b16 a[74:75], v13 offset:12288
    s_lshl_b32 s34, s25, 6
    s_add_u32 s34, s34, 32
    v_xor_b32 v13, s34, v12
    v_add_u32 v13, 65536, v13
    ds_read_b64_tr_b16 a[68:69], v13 offset:0
    ds_read_b64_tr_b16 a[70:71], v13 offset:4096
    ds_read_b64_tr_b16 a[76:77], v13 offset:8192
    ds_read_b64_tr_b16 a[78:79], v13 offset:12288
    s_waitcnt lgkmcnt(0)
    s_waitcnt vmcnt(24)
    s_barrier
    s_add_u32 s34, s31, 2097152
    s_add_u32 s34, s34, s38
    s_add_u32 m0, s37, 65536
    s_nop 0
    buffer_load_dwordx4 v10, s[20:23], s34 offen lds
    s_add_u32 s34, s31, 2129920
    s_add_u32 s34, s34, s38
    s_add_u32 m0, s37, 66560
    s_nop 0
    buffer_load_dwordx4 v11, s[20:23], s34 offen lds
    s_add_u32 s34, s31, 2162688
    s_add_u32 s34, s34, s38
    s_add_u32 m0, s37, 67584
    s_nop 0
    buffer_load_dwordx4 v10, s[20:23], s34 offen lds
    s_add_u32 s34, s31, 2195456
    s_add_u32 s34, s34, s38
    s_add_u32 m0, s37, 68608
    s_nop 0
    buffer_load_dwordx4 v11, s[20:23], s34 offen lds
    s_lshl_b32 s34, s25, 6
    s_add_u32 s34, s34, 0
    v_xor_b32 v13, s34, v12
    v_add_u32 v13, 81920, v13
    ds_read_b64_tr_b16 a[80:81], v13 offset:0
    ds_read_b64_tr_b16 a[82:83], v13 offset:4096
    ds_read_b64_tr_b16 a[88:89], v13 offset:8192
    ds_read_b64_tr_b16 a[90:91], v13 offset:12288
    s_lshl_b32 s34, s25, 6
    s_add_u32 s34, s34, 32
    v_xor_b32 v13, s34, v12
    v_add_u32 v13, 81920, v13
    ds_read_b64_tr_b16 a[84:85], v13 offset:0
    ds_read_b64_tr_b16 a[86:87], v13 offset:4096
    ds_read_b64_tr_b16 a[92:93], v13 offset:8192
    ds_read_b64_tr_b16 a[94:95], v13 offset:12288
    s_waitcnt lgkmcnt(0)
    s_waitcnt vmcnt(24)
    s_barrier
    s_add_u32 s34, s31, 2621440
    s_add_u32 s34, s34, s38
    s_add_u32 m0, s37, 81920
    s_nop 0
    buffer_load_dwordx4 v10, s[20:23], s34 offen lds
    s_add_u32 s34, s31, 2654208
    s_add_u32 s34, s34, s38
    s_add_u32 m0, s37, 82944
    s_nop 0
    buffer_load_dwordx4 v11, s[20:23], s34 offen lds
    s_add_u32 s34, s31, 2686976
    s_add_u32 s34, s34, s38
    s_add_u32 m0, s37, 83968
    s_nop 0
    buffer_load_dwordx4 v10, s[20:23], s34 offen lds
    s_add_u32 s34, s31, 2719744
    s_add_u32 s34, s34, s38
    s_add_u32 m0, s37, 84992
    s_nop 0
    buffer_load_dwordx4 v11, s[20:23], s34 offen lds
    s_lshl_b32 s34, s25, 6
    s_add_u32 s34, s34, 0
    v_xor_b32 v13, s34, v12
    v_add_u32 v13, 98304, v13
    ds_read_b64_tr_b16 a[96:97], v13 offset:0
    ds_read_b64_tr_b16 a[98:99], v13 offset:4096
    ds_read_b64_tr_b16 a[104:105], v13 offset:8192
    ds_read_b64_tr_b16 a[106:107], v13 offset:12288
    s_lshl_b32 s34, s25, 6
    s_add_u32 s34, s34, 32
    v_xor_b32 v13, s34, v12
    v_add_u32 v13, 98304, v13
    ds_read_b64_tr_b16 a[100:101], v13 offset:0
    ds_read_b64_tr_b16 a[102:103], v13 offset:4096
    ds_read_b64_tr_b16 a[108:109], v13 offset:8192
    ds_read_b64_tr_b16 a[110:111], v13 offset:12288
    s_waitcnt lgkmcnt(0)
    s_waitcnt vmcnt(24)
    s_barrier
    s_add_u32 s34, s31, 3145728
    s_add_u32 s34, s34, s38
    s_add_u32 m0, s37, 98304
    s_nop 0
    buffer_load_dwordx4 v10, s[20:23], s34 offen lds
    s_add_u32 s34, s31, 3178496
    s_add_u32 s34, s34, s38
    s_add_u32 m0, s37, 99328
    s_nop 0
    buffer_load_dwordx4 v11, s[20:23], s34 offen lds
    s_add_u32 s34, s31, 3211264
    s_add_u32 s34, s34, s38
    s_add_u32 m0, s37, 100352
    s_nop 0
    buffer_load_dwordx4 v10, s[20:23], s34 offen lds
    s_add_u32 s34, s31, 3244032
    s_add_u32 s34, s34, s38
    s_add_u32 m0, s37, 101376
    s_nop 0
    buffer_load_dwordx4 v11, s[20:23], s34 offen lds
    s_lshl_b32 s34, s25, 6
    s_add_u32 s34, s34, 0
    v_xor_b32 v13, s34, v12
    v_add_u32 v13, 114688, v13
    ds_read_b64_tr_b16 a[112:113], v13 offset:0
    ds_read_b64_tr_b16 a[114:115], v13 offset:4096
    ds_read_b64_tr_b16 a[120:121], v13 offset:8192
    ds_read_b64_tr_b16 a[122:123], v13 offset:12288
    s_lshl_b32 s34, s25, 6
    s_add_u32 s34, s34, 32
    v_xor_b32 v13, s34, v12
    v_add_u32 v13, 114688, v13
    ds_read_b64_tr_b16 a[116:117], v13 offset:0
    ds_read_b64_tr_b16 a[118:119], v13 offset:4096
    ds_read_b64_tr_b16 a[124:125], v13 offset:8192
    ds_read_b64_tr_b16 a[126:127], v13 offset:12288
    s_waitcnt lgkmcnt(0)
    s_waitcnt vmcnt(24)
    s_barrier
    s_add_u32 s34, s31, 3670016
    s_add_u32 s34, s34, s38
    s_add_u32 m0, s37, 114688
    s_nop 0
    buffer_load_dwordx4 v10, s[20:23], s34 offen lds
    s_add_u32 s34, s31, 3702784
    s_add_u32 s34, s34, s38
    s_add_u32 m0, s37, 115712
    s_nop 0
    buffer_load_dwordx4 v11, s[20:23], s34 offen lds
    s_add_u32 s34, s31, 3735552
    s_add_u32 s34, s34, s38
    s_add_u32 m0, s37, 116736
    s_nop 0
    buffer_load_dwordx4 v10, s[20:23], s34 offen lds
    s_add_u32 s34, s31, 3768320
    s_add_u32 s34, s34, s38
    s_add_u32 m0, s37, 117760
    s_nop 0
    buffer_load_dwordx4 v11, s[20:23], s34 offen lds
    s_lshl_b32 s34, s25, 6
    s_add_u32 s34, s34, 0
    v_xor_b32 v13, s34, v12
    v_add_u32 v13, 0, v13
    ds_read_b64_tr_b16 a[128:129], v13 offset:0
    ds_read_b64_tr_b16 a[130:131], v13 offset:4096
    ds_read_b64_tr_b16 a[136:137], v13 offset:8192
    ds_read_b64_tr_b16 a[138:139], v13 offset:12288
    s_lshl_b32 s34, s25, 6
    s_add_u32 s34, s34, 32
    v_xor_b32 v13, s34, v12
    v_add_u32 v13, 0, v13
    ds_read_b64_tr_b16 a[132:133], v13 offset:0
    ds_read_b64_tr_b16 a[134:135], v13 offset:4096
    ds_read_b64_tr_b16 a[140:141], v13 offset:8192
    ds_read_b64_tr_b16 a[142:143], v13 offset:12288
    s_waitcnt lgkmcnt(0)
    s_waitcnt vmcnt(24)
    s_barrier
    s_lshl_b32 s34, s25, 6
    s_add_u32 s34, s34, 0
    v_xor_b32 v13, s34, v12
    v_add_u32 v13, 16384, v13
    ds_read_b64_tr_b16 a[144:145], v13 offset:0
    ds_read_b64_tr_b16 a[146:147], v13 offset:4096
    ds_read_b64_tr_b16 a[152:153], v13 offset:8192
    ds_read_b64_tr_b16 a[154:155], v13 offset:12288
    s_lshl_b32 s34, s25, 6
    s_add_u32 s34, s34, 32
    v_xor_b32 v13, s34, v12
    v_add_u32 v13, 16384, v13
    ds_read_b64_tr_b16 a[148:149], v13 offset:0
    ds_read_b64_tr_b16 a[150:151], v13 offset:4096
    ds_read_b64_tr_b16 a[156:157], v13 offset:8192
    ds_read_b64_tr_b16 a[158:159], v13 offset:12288
    s_waitcnt lgkmcnt(0)
    s_waitcnt vmcnt(20)
    s_barrier
    s_lshl_b32 s34, s25, 6
    s_add_u32 s34, s34, 0
    v_xor_b32 v13, s34, v12
    v_add_u32 v13, 32768, v13
    ds_read_b64_tr_b16 a[160:161], v13 offset:0
    ds_read_b64_tr_b16 a[162:163], v13 offset:4096
    ds_read_b64_tr_b16 a[168:169], v13 offset:8192
    ds_read_b64_tr_b16 a[170:171], v13 offset:12288
    s_lshl_b32 s34, s25, 6
    s_add_u32 s34, s34, 32
    v_xor_b32 v13, s34, v12
    v_add_u32 v13, 32768, v13
    ds_read_b64_tr_b16 a[164:165], v13 offset:0
    ds_read_b64_tr_b16 a[166:167], v13 offset:4096
    ds_read_b64_tr_b16 a[172:173], v13 offset:8192
    ds_read_b64_tr_b16 a[174:175], v13 offset:12288
    s_waitcnt lgkmcnt(0)
    s_waitcnt vmcnt(16)
    s_barrier
    s_lshl_b32 s34, s25, 6
    s_add_u32 s34, s34, 0
    v_xor_b32 v13, s34, v12
    v_add_u32 v13, 49152, v13
    ds_read_b64_tr_b16 a[176:177], v13 offset:0
    ds_read_b64_tr_b16 a[178:179], v13 offset:4096
    ds_read_b64_tr_b16 a[184:185], v13 offset:8192
    ds_read_b64_tr_b16 a[186:187], v13 offset:12288
    s_lshl_b32 s34, s25, 6
    s_add_u32 s34, s34, 32
    v_xor_b32 v13, s34, v12
    v_add_u32 v13, 49152, v13
    ds_read_b64_tr_b16 a[180:181], v13 offset:0
    ds_read_b64_tr_b16 a[182:183], v13 offset:4096
    ds_read_b64_tr_b16 a[188:189], v13 offset:8192
    ds_read_b64_tr_b16 a[190:191], v13 offset:12288
    s_waitcnt lgkmcnt(0)
    s_waitcnt vmcnt(12)
    s_barrier
    s_lshl_b32 s34, s25, 6
    s_add_u32 s34, s34, 0
    v_xor_b32 v13, s34, v12
    v_add_u32 v13, 65536, v13
    ds_read_b64_tr_b16 a[192:193], v13 offset:0
    ds_read_b64_tr_b16 a[194:195], v13 offset:4096
    ds_read_b64_tr_b16 a[200:201], v13 offset:8192
    ds_read_b64_tr_b16 a[202:203], v13 offset:12288
    s_lshl_b32 s34, s25, 6
    s_add_u32 s34, s34, 32
    v_xor_b32 v13, s34, v12
    v_add_u32 v13, 65536, v13
    ds_read_b64_tr_b16 a[196:197], v13 offset:0
    ds_read_b64_tr_b16 a[198:199], v13 offset:4096
    ds_read_b64_tr_b16 a[204:205], v13 offset:8192
    ds_read_b64_tr_b16 a[206:207], v13 offset:12288
    s_waitcnt lgkmcnt(0)
    s_waitcnt vmcnt(8)
    s_barrier
    s_lshl_b32 s34, s25, 6
    s_add_u32 s34, s34, 0
    v_xor_b32 v13, s34, v12
    v_add_u32 v13, 81920, v13
    ds_read_b64_tr_b16 a[208:209], v13 offset:0
    ds_read_b64_tr_b16 a[210:211], v13 offset:4096
    ds_read_b64_tr_b16 a[216:217], v13 offset:8192
    ds_read_b64_tr_b16 a[218:219], v13 offset:12288
    s_lshl_b32 s34, s25, 6
    s_add_u32 s34, s34, 32
    v_xor_b32 v13, s34, v12
    v_add_u32 v13, 81920, v13
    ds_read_b64_tr_b16 a[212:213], v13 offset:0
    ds_read_b64_tr_b16 a[214:215], v13 offset:4096
    ds_read_b64_tr_b16 a[220:221], v13 offset:8192
    ds_read_b64_tr_b16 a[222:223], v13 offset:12288
    s_waitcnt lgkmcnt(0)
    s_waitcnt vmcnt(4)
    s_barrier
    s_lshl_b32 s34, s25, 6
    s_add_u32 s34, s34, 0
    v_xor_b32 v13, s34, v12
    v_add_u32 v13, 98304, v13
    ds_read_b64_tr_b16 a[224:225], v13 offset:0
    ds_read_b64_tr_b16 a[226:227], v13 offset:4096
    ds_read_b64_tr_b16 a[232:233], v13 offset:8192
    ds_read_b64_tr_b16 a[234:235], v13 offset:12288
    s_lshl_b32 s34, s25, 6
    s_add_u32 s34, s34, 32
    v_xor_b32 v13, s34, v12
    v_add_u32 v13, 98304, v13
    ds_read_b64_tr_b16 a[228:229], v13 offset:0
    ds_read_b64_tr_b16 a[230:231], v13 offset:4096
    ds_read_b64_tr_b16 a[236:237], v13 offset:8192
    ds_read_b64_tr_b16 a[238:239], v13 offset:12288
    s_waitcnt lgkmcnt(0)
    s_waitcnt vmcnt(0)
    s_barrier
    s_lshl_b32 s34, s25, 6
    s_add_u32 s34, s34, 0
    v_xor_b32 v13, s34, v12
    v_add_u32 v13, 114688, v13
    ds_read_b64_tr_b16 a[240:241], v13 offset:0
    ds_read_b64_tr_b16 a[242:243], v13 offset:4096
    ds_read_b64_tr_b16 a[248:249], v13 offset:8192
    ds_read_b64_tr_b16 a[250:251], v13 offset:12288
    s_lshl_b32 s34, s25, 6
    s_add_u32 s34, s34, 32
    v_xor_b32 v13, s34, v12
    v_add_u32 v13, 114688, v13
    ds_read_b64_tr_b16 a[244:245], v13 offset:0
    ds_read_b64_tr_b16 a[246:247], v13 offset:4096
    ds_read_b64_tr_b16 a[252:253], v13 offset:8192
    ds_read_b64_tr_b16 a[254:255], v13 offset:12288
    s_waitcnt lgkmcnt(0)
    s_mov_b32 s34, 128
    s_mov_b32 s35, 128
    v_mov_b32 v8, 0
KV_wln:
    buffer_load_dword v9, v8, s[40:43], s34 offen sc1
    s_waitcnt vmcnt(0)
    v_readfirstlane_b32 s36, v9
    s_nop 1
    s_cmp_ge_u32 s36, s35
    s_nop 1
    s_cbranch_scc1 KV_wln_ok
    s_cmp_eq_u32 s33, 0
    s_cbranch_scc1 KV_wln_ok
    s_sub_u32 s33, s33, 1
    s_sleep 2
    s_branch KV_wln
KV_wln_ok:
    s_mov_b32 s26, s29
    s_mov_b32 s27, 0
    s_barrier
    s_lshl_b32 s34, s26, 15
    s_lshl_b32 s35, s25, 13
    s_add_u32 s34, s34, s35
    s_add_u32 s35, s35, s27
    s_mov_b32 m0, s35
    s_nop 0
    buffer_load_dwordx4 v1, s[8:11], s34 offen offset:0 sc1 lds
    buffer_load_dwordx4 v1, s[8:11], s34 offen offset:1024 sc1 lds
    buffer_load_dwordx4 v1, s[8:11], s34 offen offset:2048 sc1 lds
    buffer_load_dwordx4 v1, s[8:11], s34 offen offset:3072 sc1 lds
    s_add_u32 m0, s35, 4096
    s_add_u32 s34, s34, 4096
    buffer_load_dwordx4 v1, s[8:11], s34 offen offset:0 sc1 lds
    buffer_load_dwordx4 v1, s[8:11], s34 offen offset:1024 sc1 lds
    buffer_load_dwordx4 v1, s[8:11], s34 offen offset:2048 sc1 lds
    buffer_load_dwordx4 v1, s[8:11], s34 offen offset:3072 sc1 lds
    s_waitcnt vmcnt(0)
    s_barrier
KV_loop:
    s_add_u32 s48, s26, 7
    s_xor_b32 s32, s27, 32768
    s_cmp_ge_u32 s48, 64
    s_cbranch_scc1 KV_nopf
    s_lshl_b32 s34, s48, 15
    s_lshl_b32 s35, s25, 13
    s_add_u32 s34, s34, s35
    s_add_u32 s35, s35, s32
    s_mov_b32 m0, s35
    s_nop 0
    buffer_load_dwordx4 v1, s[8:11], s34 offen offset:0 sc1 lds
    buffer_load_dwordx4 v1, s[8:11], s34 offen offset:1024 sc1 lds
    buffer_load_dwordx4 v1, s[8:11], s34 offen offset:2048 sc1 lds
    buffer_load_dwordx4 v1, s[8:11], s34 offen offset:3072 sc1 lds
    s_add_u32 m0, s35, 4096
    s_add_u32 s34, s34, 4096
    buffer_load_dwordx4 v1, s[8:11], s34 offen offset:0 sc1 lds
    buffer_load_dwordx4 v1, s[8:11], s34 offen offset:1024 sc1 lds
    buffer_load_dwordx4 v1, s[8:11], s34 offen offset:2048 sc1 lds
    buffer_load_dwordx4 v1, s[8:11], s34 offen offset:3072 sc1 lds
KV_nopf:
    v_add_u32 v8, s27, v1
    ds_read_b128 v[16:19], v8 offset:0
    ds_read_b128 v[20:23], v8 offset:16384
    ds_read_b128 v[24:27], v8 offset:1024
    ds_read_b128 v[28:31], v8 offset:17408
    s_waitcnt lgkmcnt(3)
    v_mfma_f32_16x16x32_bf16 v[40:43], a[0:3], v[16:19], 0
    ds_read_b128 v[32:35], v8 offset:2048
    s_waitcnt lgkmcnt(3)
    v_mfma_f32_16x16x32_bf16 v[48:51], a[0:3], v[20:23], 0
    ds_read_b128 v[36:39], v8 offset:18432
    v_mfma_f32_16x16x32_bf16 v[44:47], a[4:7], v[16:19], 0
    v_mfma_f32_16x16x32_bf16 v[52:55], a[4:7], v[20:23], 0
    v_mfma_f32_16x16x32_bf16 v[56:59], v[16:19], a[128:131], 0
    v_mfma_f32_16x16x32_bf16 v[60:63], v[20:23], a[128:131], 0
    v_mfma_f32_16x16x32_bf16 v[64:67], v[16:19], a[132:135], 0
    v_mfma_f32_16x16x32_bf16 v[68:71], v[20:23], a[132:135], 0
    s_waitcnt lgkmcnt(3)
    v_mfma_f32_16x16x32_bf16 v[40:43], a[8:11], v[24:27], v[40:43]
    ds_read_b128 v[16:19], v8 offset:3072
    s_waitcnt lgkmcnt(3)
    v_mfma_f32_16x16x32_bf16 v[48:51], a[8:11], v[28:31], v[48:51]
    ds_read_b128 v[20:23], v8 offset:19456
    v_mfma_f32_16x16x32_bf16 v[44:47], a[12:15], v[24:27], v[44:47]
    v_mfma_f32_16x16x32_bf16 v[52:55], a[12:15], v[28:31], v[52:55]
    v_mfma_f32_16x16x32_bf16 v[56:59], v[24:27], a[136:139], v[56:59]
    v_mfma_f32_16x16x32_bf16 v[60:63], v[28:31], a[136:139], v[60:63]
    v_mfma_f32_16x16x32_bf16 v[64:67], v[24:27], a[140:143], v[64:67]
    v_mfma_f32_16x16x32_bf16 v[68:71], v[28:31], a[140:143], v[68:71]
    s_waitcnt lgkmcnt(3)
    v_mfma_f32_16x16x32_bf16 v[40:43], a[16:19], v[32:35], v[40:43]
    ds_read_b128 v[24:27], v8 offset:4096
    s_waitcnt lgkmcnt(3)
    v_mfma_f32_16x16x32_bf16 v[48:51], a[16:19], v[36:39], v[48:51]
    ds_read_b128 v[28:31], v8 offset:20480
    v_mfma_f32_16x16x32_bf16 v[44:47], a[20:23], v[32:35], v[44:47]
    v_mfma_f32_16x16x32_bf16 v[52:55], a[20:23], v[36:39], v[52:55]
    v_mfma_f32_16x16x32_bf16 v[56:59], v[32:35], a[144:147], v[56:59]
    v_mfma_f32_16x16x32_bf16 v[60:63], v[36:39], a[144:147], v[60:63]
    v_mfma_f32_16x16x32_bf16 v[64:67], v[32:35], a[148:151], v[64:67]
    v_mfma_f32_16x16x32_bf16 v[68:71], v[36:39], a[148:151], v[68:71]
    s_waitcnt lgkmcnt(3)
    v_mfma_f32_16x16x32_bf16 v[40:43], a[24:27], v[16:19], v[40:43]
    ds_read_b128 v[32:35], v8 offset:5120
    s_waitcnt lgkmcnt(3)
    v_mfma_f32_16x16x32_bf16 v[48:51], a[24:27], v[20:23], v[48:51]
    ds_read_b128 v[36:39], v8 offset:21504
    v_mfma_f32_16x16x32_bf16 v[44:47], a[28:31], v[16:19], v[44:47]
    v_mfma_f32_16x16x32_bf16 v[52:55], a[28:31], v[20:23], v[52:55]
    v_mfma_f32_16x16x32_bf16 v[56:59], v[16:19], a[152:155], v[56:59]
    v_mfma_f32_16x16x32_bf16 v[60:63], v[20:23], a[152:155], v[60:63]
    v_mfma_f32_16x16x32_bf16 v[64:67], v[16:19], a[156:159], v[64:67]
    v_mfma_f32_16x16x32_bf16 v[68:71], v[20:23], a[156:159], v[68:71]
    s_waitcnt lgkmcnt(3)
    v_mfma_f32_16x16x32_bf16 v[40:43], a[32:35], v[24:27], v[40:43]
    ds_read_b128 v[16:19], v8 offset:6144
    s_waitcnt lgkmcnt(3)
    v_mfma_f32_16x16x32_bf16 v[48:51], a[32:35], v[28:31], v[48:51]
    ds_read_b128 v[20:23], v8 offset:22528
    v_mfma_f32_16x16x32_bf16 v[44:47], a[36:39], v[24:27], v[44:47]
    v_mfma_f32_16x16x32_bf16 v[52:55], a[36:39], v[28:31], v[52:55]
    v_mfma_f32_16x16x32_bf16 v[56:59], v[24:27], a[160:163], v[56:59]
    v_mfma_f32_16x16x32_bf16 v[60:63], v[28:31], a[160:163], v[60:63]
    v_mfma_f32_16x16x32_bf16 v[64:67], v[24:27], a[164:167], v[64:67]
    v_mfma_f32_16x16x32_bf16 v[68:71], v[28:31], a[164:167], v[68:71]
    s_waitcnt lgkmcnt(3)
    v_mfma_f32_16x16x32_bf16 v[40:43], a[40:43], v[32:35], v[40:43]
    ds_read_b128 v[24:27], v8 offset:7168
    s_waitcnt lgkmcnt(3)
    v_mfma_f32_16x16x32_bf16 v[48:51], a[40:43], v[36:39], v[48:51]
    ds_read_b128 v[28:31], v8 offset:23552
    v_mfma_f32_16x16x32_bf16 v[44:47], a[44:47], v[32:35], v[44:47]
    v_mfma_f32_16x16x32_bf16 v[52:55], a[44:47], v[36:39], v[52:55]
    v_mfma_f32_16x16x32_bf16 v[56:59], v[32:35], a[168:171], v[56:59]
    v_mfma_f32_16x16x32_bf16 v[60:63], v[36:39], a[168:171], v[60:63]
    v_mfma_f32_16x16x32_bf16 v[64:67], v[32:35], a[172:175], v[64:67]
    v_mfma_f32_16x16x32_bf16 v[68:71], v[36:39], a[172:175], v[68:71]
    s_waitcnt lgkmcnt(3)
    v_mfma_f32_16x16x32_bf16 v[40:43], a[48:51], v[16:19], v[40:43]
    ds_read_b128 v[32:35], v8 offset:8192
    s_waitcnt lgkmcnt(3)
    v_mfma_f32_16x16x32_bf16 v[48:51], a[48:51], v[20:23], v[48:51]
    ds_read_b128 v[36:39], v8 offset:24576
    v_mfma_f32_16x16x32_bf16 v[44:47], a[52:55], v[16:19], v[44:47]
    v_mfma_f32_16x16x32_bf16 v[52:55], a[52:55], v[20:23], v[52:55]
    v_mfma_f32_16x16x32_bf16 v[56:59], v[16:19], a[176:179], v[56:59]
    v_mfma_f32_16x16x32_bf16 v[60:63], v[20:23], a[176:179], v[60:63]
    v_mfma_f32_16x16x32_bf16 v[64:67], v[16:19], a[180:183], v[64:67]
    v_mfma_f32_16x16x32_bf16 v[68:71], v[20:23], a[180:183], v[68:71]
    s_waitcnt lgkmcnt(3)
    v_mfma_f32_16x16x32_bf16 v[40:43], a[56:59], v[24:27], v[40:43]
    ds_read_b128 v[16:19], v8 offset:9216
    s_waitcnt lgkmcnt(3)
    v_mfma_f32_16x16x32_bf16 v[48:51], a[56:59], v[28:31], v[48:51]
    ds_read_b128 v[20:23], v8 offset:25600
    v_mfma_f32_16x16x32_bf16 v[44:47], a[60:63], v[24:27], v[44:47]
    v_mfma_f32_16x16x32_bf16 v[52:55], a[60:63], v[28:31], v[52:55]
    v_mfma_f32_16x16x32_bf16 v[56:59], v[24:27], a[184:187], v[56:59]
    v_mfma_f32_16x16x32_bf16 v[60:63], v[28:31], a[184:187], v[60:63]
    v_mfma_f32_16x16x32_bf16 v[64:67], v[24:27], a[188:191], v[64:67]
    v_mfma_f32_16x16x32_bf16 v[68:71], v[28:31], a[188:191], v[68:71]
    s_waitcnt lgkmcnt(3)
    v_mfma_f32_16x16x32_bf16 v[40:43], a[64:67], v[32:35], v[40:43]
    ds_read_b128 v[24:27], v8 offset:10240
    s_waitcnt lgkmcnt(3)
    v_mfma_f32_16x16x32_bf16 v[48:51], a[64:67], v[36:39], v[48:51]
    ds_read_b128 v[28:31], v8 offset:26624
    v_mfma_f32_16x16x32_bf16 v[44:47], a[68:71], v[32:35], v[44:47]
    v_mfma_f32_16x16x32_bf16 v[52:55], a[68:71], v[36:39], v[52:55]
    v_mfma_f32_16x16x32_bf16 v[56:59], v[32:35], a[192:195], v[56:59]
    v_mfma_f32_16x16x32_bf16 v[60:63], v[36:39], a[192:195], v[60:63]
    v_mfma_f32_16x16x32_bf16 v[64:67], v[32:35], a[196:199], v[64:67]
    v_mfma_f32_16x16x32_bf16 v[68:71], v[36:39], a[196:199], v[68:71]
    s_waitcnt lgkmcnt(3)
    v_mfma_f32_16x16x32_bf16 v[40:43], a[72:75], v[16:19], v[40:43]
    ds_read_b128 v[32:35], v8 offset:11264
    s_waitcnt lgkmcnt(3)
    v_mfma_f32_16x16x32_bf16 v[48:51], a[72:75], v[20:23], v[48:51]
    ds_read_b128 v[36:39], v8 offset:27648
    v_mfma_f32_16x16x32_bf16 v[44:47], a[76:79], v[16:19], v[44:47]
    v_mfma_f32_16x16x32_bf16 v[52:55], a[76:79], v[20:23], v[52:55]
    v_mfma_f32_16x16x32_bf16 v[56:59], v[16:19], a[200:203], v[56:59]
    v_mfma_f32_16x16x32_bf16 v[60:63], v[20:23], a[200:203], v[60:63]
    v_mfma_f32_16x16x32_bf16 v[64:67], v[16:19], a[204:207], v[64:67]
    v_mfma_f32_16x16x32_bf16 v[68:71], v[20:23], a[204:207], v[68:71]
    s_waitcnt lgkmcnt(3)
    v_mfma_f32_16x16x32_bf16 v[40:43], a[80:83], v[24:27], v[40:43]
    ds_read_b128 v[16:19], v8 offset:12288
    s_waitcnt lgkmcnt(3)
    v_mfma_f32_16x16x32_bf16 v[48:51], a[80:83], v[28:31], v[48:51]
    ds_read_b128 v[20:23], v8 offset:28672
    v_mfma_f32_16x16x32_bf16 v[44:47], a[84:87], v[24:27], v[44:47]
    v_mfma_f32_16x16x32_bf16 v[52:55], a[84:87], v[28:31], v[52:55]
    v_mfma_f32_16x16x32_bf16 v[56:59], v[24:27], a[208:211], v[56:59]
    v_mfma_f32_16x16x32_bf16 v[60:63], v[28:31], a[208:211], v[60:63]
    v_mfma_f32_16x16x32_bf16 v[64:67], v[24:27], a[212:215], v[64:67]
    v_mfma_f32_16x16x32_bf16 v[68:71], v[28:31], a[212:215], v[68:71]
    s_waitcnt lgkmcnt(3)
    v_mfma_f32_16x16x32_bf16 v[40:43], a[88:91], v[32:35], v[40:43]
    ds_read_b128 v[24:27], v8 offset:13312
    s_waitcnt lgkmcnt(3)
    v_mfma_f32_16x16x32_bf16 v[48:51], a[88:91], v[36:39], v[48:51]
    ds_read_b128 v[28:31], v8 offset:29696
    v_mfma_f32_16x16x32_bf16 v[44:47], a[92:95], v[32:35], v[44:47]
    v_mfma_f32_16x16x32_bf16 v[52:55], a[92:95], v[36:39], v[52:55]
    v_mfma_f32_16x16x32_bf16 v[56:59], v[32:35], a[216:219], v[56:59]
    v_mfma_f32_16x16x32_bf16 v[60:63], v[36:39], a[216:219], v[60:63]
    v_mfma_f32_16x16x32_bf16 v[64:67], v[32:35], a[220:223], v[64:67]
    v_mfma_f32_16x16x32_bf16 v[68:71], v[36:39], a[220:223], v[68:71]
    s_waitcnt lgkmcnt(3)
    v_mfma_f32_16x16x32_bf16 v[40:43], a[96:99], v[16:19], v[40:43]
    ds_read_b128 v[32:35], v8 offset:14336
    s_waitcnt lgkmcnt(3)
    v_mfma_f32_16x16x32_bf16 v[48:51], a[96:99], v[20:23], v[48:51]
    ds_read_b128 v[36:39], v8 offset:30720
    v_mfma_f32_16x16x32_bf16 v[44:47], a[100:103], v[16:19], v[44:47]
    v_mfma_f32_16x16x32_bf16 v[52:55], a[100:103], v[20:23], v[52:55]
    v_mfma_f32_16x16x32_bf16 v[56:59], v[16:19], a[224:227], v[56:59]
    v_mfma_f32_16x16x32_bf16 v[60:63], v[20:23], a[224:227], v[60:63]
    v_mfma_f32_16x16x32_bf16 v[64:67], v[16:19], a[228:231], v[64:67]
    v_mfma_f32_16x16x32_bf16 v[68:71], v[20:23], a[228:231], v[68:71]
    s_waitcnt lgkmcnt(3)
    v_mfma_f32_16x16x32_bf16 v[40:43], a[104:107], v[24:27], v[40:43]
    ds_read_b128 v[16:19], v8 offset:15360
    s_waitcnt lgkmcnt(3)
    v_mfma_f32_16x16x32_bf16 v[48:51], a[104:107], v[28:31], v[48:51]
    ds_read_b128 v[20:23], v8 offset:31744
    v_mfma_f32_16x16x32_bf16 v[44:47], a[108:111], v[24:27], v[44:47]
    v_mfma_f32_16x16x32_bf16 v[52:55], a[108:111], v[28:31], v[52:55]
    v_mfma_f32_16x16x32_bf16 v[56:59], v[24:27], a[232:235], v[56:59]
    v_mfma_f32_16x16x32_bf16 v[60:63], v[28:31], a[232:235], v[60:63]
    v_mfma_f32_16x16x32_bf16 v[64:67], v[24:27], a[236:239], v[64:67]
    v_mfma_f32_16x16x32_bf16 v[68:71], v[28:31], a[236:239], v[68:71]
    s_waitcnt lgkmcnt(3)
    v_mfma_f32_16x16x32_bf16 v[40:43], a[112:115], v[32:35], v[40:43]
    s_waitcnt lgkmcnt(2)
    v_mfma_f32_16x16x32_bf16 v[48:51], a[112:115], v[36:39], v[48:51]
    v_mfma_f32_16x16x32_bf16 v[44:47], a[116:119], v[32:35], v[44:47]
    v_mfma_f32_16x16x32_bf16 v[52:55], a[116:119], v[36:39], v[52:55]
    v_mfma_f32_16x16x32_bf16 v[56:59], v[32:35], a[240:243], v[56:59]
    v_mfma_f32_16x16x32_bf16 v[60:63], v[36:39], a[240:243], v[60:63]
    v_mfma_f32_16x16x32_bf16 v[64:67], v[32:35], a[244:247], v[64:67]
    v_mfma_f32_16x16x32_bf16 v[68:71], v[36:39], a[244:247], v[68:71]
    s_waitcnt lgkmcnt(1)
    v_mfma_f32_16x16x32_bf16 v[40:43], a[120:123], v[16:19], v[40:43]
    s_waitcnt lgkmcnt(0)
    v_mfma_f32_16x16x32_bf16 v[48:51], a[120:123], v[20:23], v[48:51]
    v_mfma_f32_16x16x32_bf16 v[44:47], a[124:127], v[16:19], v[44:47]
    v_mfma_f32_16x16x32_bf16 v[52:55], a[124:127], v[20:23], v[52:55]
    v_mfma_f32_16x16x32_bf16 v[56:59], v[16:19], a[248:251], v[56:59]
    v_mfma_f32_16x16x32_bf16 v[60:63], v[20:23], a[248:251], v[60:63]
    v_mfma_f32_16x16x32_bf16 v[64:67], v[16:19], a[252:255], v[64:67]
    v_mfma_f32_16x16x32_bf16 v[68:71], v[20:23], a[252:255], v[68:71]
    s_lshl_b32 s34, s26, 5
    s_add_u32 s34, s34, s28
    s_lshl_b32 s34, s34, 2
    s_add_u32 s34, s34, s25
    s_lshl_b32 s34, s34, 12
    v_cvt_pk_bf16_f32 v72, v40, v41
    v_cvt_pk_bf16_f32 v73, v42, v43
    v_cvt_pk_bf16_f32 v74, v44, v45
    v_cvt_pk_bf16_f32 v75, v46, v47
    buffer_store_dwordx4 v[72:75], v1, s[12:15], s34 offen offset:0 sc1
    v_cvt_pk_bf16_f32 v76, v48, v49
    v_cvt_pk_bf16_f32 v77, v50, v51
    v_cvt_pk_bf16_f32 v78, v52, v53
    v_cvt_pk_bf16_f32 v79, v54, v55
    buffer_store_dwordx4 v[76:79], v1, s[12:15], s34 offen offset:1024 sc1
    v_cvt_pk_bf16_f32 v80, v56, v57
    v_cvt_pk_bf16_f32 v81, v58, v59
    v_cvt_pk_bf16_f32 v82, v60, v61
    v_cvt_pk_bf16_f32 v83, v62, v63
    buffer_store_dwordx4 v[80:83], v1, s[12:15], s34 offen offset:2048 sc1
    v_cvt_pk_bf16_f32 v84, v64, v65
    v_cvt_pk_bf16_f32 v85, v66, v67
    v_cvt_pk_bf16_f32 v86, v68, v69
    v_cvt_pk_bf16_f32 v87, v70, v71
    buffer_store_dwordx4 v[84:87], v1, s[12:15], s34 offen offset:3072 sc1
    s_add_u32 s34, s29, 7
    s_cmp_lg_u32 s26, s34
    s_cbranch_scc1 KV_noearly
    s_waitcnt vmcnt(0)
    s_barrier
    s_cmp_lg_u32 s25, 0
    s_cbranch_scc1 KV_kv0_noarr
    v_mov_b32 v8, 1
    s_mov_b32 s34, 512
    s_mov_b64 exec, 1
    buffer_atomic_add v8, v7, s[40:43], s34 offen
    s_mov_b64 exec, -1
KV_kv0_noarr:
    s_mov_b32 s34, 0
    s_mov_b32 s35, 32
    v_mov_b32 v9, 0
KV_wcw:
    buffer_load_dword v10, v9, s[40:43], s34 offen sc1
    s_waitcnt vmcnt(0)
    v_readfirstlane_b32 s36, v10
    s_nop 1
    s_cmp_ge_u32 s36, s35
    s_nop 1
    s_cbranch_scc1 KV_wcw_ok
    s_cmp_eq_u32 s33, 0
    s_cbranch_scc1 KV_wcw_ok
    s_sub_u32 s33, s33, 1
    s_sleep 2
    s_branch KV_wcw
KV_wcw_ok:
KV_noearly:
    s_waitcnt vmcnt(4)
    s_barrier
    s_mov_b32 s26, s48
    s_mov_b32 s27, s32
    s_cmp_lt_u32 s26, 64
    s_cbranch_scc1 KV_loop
    s_waitcnt vmcnt(0)
    s_barrier
    s_cmp_lg_u32 s25, 0
    s_cbranch_scc1 KV_kv_noarr
    v_mov_b32 v8, 1
    s_mov_b32 s34, 256
    s_mov_b64 exec, 1
    buffer_atomic_add v8, v7, s[40:43], s34 offen
    s_mov_b64 exec, -1
KV_kv_noarr:
    s_lshr_b32 s28, s24, 4
    s_and_b32 s29, s24, 15
    s_lshl_b32 s31, s28, 8
    s_lshl_b32 s34, s25, 6
    s_add_u32 s32, s31, s34
    s_load_dwordx2 s[46:47], s[0:1], 64
    s_waitcnt lgkmcnt(0)
    s_mov_b32 s4, s46
    s_mov_b32 s5, s47
    s_mov_b32 s6, 1835008
    s_mov_b32 s7, 0x20000
    s_load_dwordx2 s[46:47], s[0:1], 72
    s_waitcnt lgkmcnt(0)
    s_mov_b32 s20, s46
    s_mov_b32 s21, s47
    s_mov_b32 s22, 3584
    s_mov_b32 s23, 0x20000
    s_add_u32 s16, s44, 58720256
    s_addc_u32 s17, s45, 0
    s_mov_b32 s18, 7340032
    s_mov_b32 s19, 0x20000
    v_lshlrev_b32 v8, 3, v5
    buffer_load_dwordx2 v[80:81], v8, s[20:23], s32 offen offset:0
    buffer_load_dwordx2 v[82:83], v8, s[20:23], s32 offen offset:32
    s_waitcnt vmcnt(1)
    v_lshlrev_b32 v72, 16, v80
    v_and_b32 v73, 0xffff0000, v80
    v_lshlrev_b32 v74, 16, v81
    v_and_b32 v75, 0xffff0000, v81
    s_waitcnt vmcnt(0)
    v_lshlrev_b32 v76, 16, v82
    v_and_b32 v77, 0xffff0000, v82
    v_lshlrev_b32 v78, 16, v83
    v_and_b32 v79, 0xffff0000, v83
    v_lshrrev_b32 v14, 4, v3
    s_mov_b32 s34, 3584
    v_mul_lo_u32 v10, v14, s34
    v_lshlrev_b32 v14, 1, v14
    v_xor_b32 v14, v14, v4
    v_lshl_add_u32 v10, v14, 4, v10
    v_xor_b32 v11, 0x80, v10
    v_bfe_u32 v14, v3, 2, 2
    v_lshl_add_u32 v15, v5, 2, v14
    v_lshlrev_b32 v12, 8, v15
    v_lshlrev_b32 v14, 1, v14
    v_and_b32 v15, 1, v5
    v_lshl_add_u32 v14, v15, 3, v14
    v_bfe_u32 v15, v3, 1, 1
    v_xor_b32 v14, v14, v15
    v_lshl_add_u32 v12, v14, 4, v12
    v_and_b32 v15, 1, v3
    v_lshl_add_u32 v12, v15, 3, v12
    s_mul_i32 s38, s25, 57344
    s_lshl_b32 s37, s25, 12
    s_waitcnt vmcnt(0) lgkmcnt(0)
    s_barrier
    s_add_u32 s34, s31, 0
    s_add_u32 s34, s34, s38
    s_add_u32 m0, s37, 0
    s_nop 0
    buffer_load_dwordx4 v10, s[4:7], s34 offen lds
    s_add_u32 s34, s31, 14336
    s_add_u32 s34, s34, s38
    s_add_u32 m0, s37, 1024
    s_nop 0
    buffer_load_dwordx4 v11, s[4:7], s34 offen lds
    s_add_u32 s34, s31, 28672
    s_add_u32 s34, s34, s38
    s_add_u32 m0, s37, 2048
    s_nop 0
    buffer_load_dwordx4 v10, s[4:7], s34 offen lds
    s_add_u32 s34, s31, 43008
    s_add_u32 s34, s34, s38
    s_add_u32 m0, s37, 3072
    s_nop 0
    buffer_load_dwordx4 v11, s[4:7], s34 offen lds
    s_add_u32 s34, s31, 229376
    s_add_u32 s34, s34, s38
    s_add_u32 m0, s37, 16384
    s_nop 0
    buffer_load_dwordx4 v10, s[4:7], s34 offen lds
    s_add_u32 s34, s31, 243712
    s_add_u32 s34, s34, s38
    s_add_u32 m0, s37, 17408
    s_nop 0
    buffer_load_dwordx4 v11, s[4:7], s34 offen lds
    s_add_u32 s34, s31, 258048
    s_add_u32 s34, s34, s38
    s_add_u32 m0, s37, 18432
    s_nop 0
    buffer_load_dwordx4 v10, s[4:7], s34 offen lds
    s_add_u32 s34, s31, 272384
    s_add_u32 s34, s34, s38
    s_add_u32 m0, s37, 19456
    s_nop 0
    buffer_load_dwordx4 v11, s[4:7], s34 offen lds
    s_add_u32 s34, s31, 458752
    s_add_u32 s34, s34, s38
    s_add_u32 m0, s37, 32768
    s_nop 0
    buffer_load_dwordx4 v10, s[4:7], s34 offen lds
    s_add_u32 s34, s31, 473088
    s_add_u32 s34, s34, s38
    s_add_u32 m0, s37, 33792
    s_nop 0
    buffer_load_dwordx4 v11, s[4:7], s34 offen lds
    s_add_u32 s34, s31, 487424
    s_add_u32 s34, s34, s38
    s_add_u32 m0, s37, 34816
    s_nop 0
    buffer_load_dwordx4 v10, s[4:7], s34 offen lds
    s_add_u32 s34, s31, 501760
    s_add_u32 s34, s34, s38
    s_add_u32 m0, s37, 35840
    s_nop 0
    buffer_load_dwordx4 v11, s[4:7], s34 offen lds
    s_add_u32 s34, s31, 688128
    s_add_u32 s34, s34, s38
    s_add_u32 m0, s37, 49152
    s_nop 0
    buffer_load_dwordx4 v10, s[4:7], s34 offen lds
    s_add_u32 s34, s31, 702464
    s_add_u32 s34, s34, s38
    s_add_u32 m0, s37, 50176
    s_nop 0
    buffer_load_dwordx4 v11, s[4:7], s34 offen lds
    s_add_u32 s34, s31, 716800
    s_add_u32 s34, s34, s38
    s_add_u32 m0, s37, 51200
    s_nop 0
    buffer_load_dwordx4 v10, s[4:7], s34 offen lds
    s_add_u32 s34, s31, 731136
    s_add_u32 s34, s34, s38
    s_add_u32 m0, s37, 52224
    s_nop 0
    buffer_load_dwordx4 v11, s[4:7], s34 offen lds
    s_add_u32 s34, s31, 917504
    s_add_u32 s34, s34, s38
    s_add_u32 m0, s37, 65536
    s_nop 0
    buffer_load_dwordx4 v10, s[4:7], s34 offen lds
    s_add_u32 s34, s31, 931840
    s_add_u32 s34, s34, s38
    s_add_u32 m0, s37, 66560
    s_nop 0
    buffer_load_dwordx4 v11, s[4:7], s34 offen lds
    s_add_u32 s34, s31, 946176
    s_add_u32 s34, s34, s38
    s_add_u32 m0, s37, 67584
    s_nop 0
    buffer_load_dwordx4 v10, s[4:7], s34 offen lds
    s_add_u32 s34, s31, 960512
    s_add_u32 s34, s34, s38
    s_add_u32 m0, s37, 68608
    s_nop 0
    buffer_load_dwordx4 v11, s[4:7], s34 offen lds
    s_add_u32 s34, s31, 1146880
    s_add_u32 s34, s34, s38
    s_add_u32 m0, s37, 81920
    s_nop 0
    buffer_load_dwordx4 v10, s[4:7], s34 offen lds
    s_add_u32 s34, s31, 1161216
    s_add_u32 s34, s34, s38
    s_add_u32 m0, s37, 82944
    s_nop 0
    buffer_load_dwordx4 v11, s[4:7], s34 offen lds
    s_add_u32 s34, s31, 1175552
    s_add_u32 s34, s34, s38
    s_add_u32 m0, s37, 83968
    s_nop 0
    buffer_load_dwordx4 v10, s[4:7], s34 offen lds
    s_add_u32 s34, s31, 1189888
    s_add_u32 s34, s34, s38
    s_add_u32 m0, s37, 84992
    s_nop 0
    buffer_load_dwordx4 v11, s[4:7], s34 offen lds
    s_add_u32 s34, s31, 1376256
    s_add_u32 s34, s34, s38
    s_add_u32 m0, s37, 98304
    s_nop 0
    buffer_load_dwordx4 v10, s[4:7], s34 offen lds
    s_add_u32 s34, s31, 1390592
    s_add_u32 s34, s34, s38
    s_add_u32 m0, s37, 99328
    s_nop 0
    buffer_load_dwordx4 v11, s[4:7], s34 offen lds
    s_add_u32 s34, s31, 1404928
    s_add_u32 s34, s34, s38
    s_add_u32 m0, s37, 100352
    s_nop 0
    buffer_load_dwordx4 v10, s[4:7], s34 offen lds
    s_add_u32 s34, s31, 1419264
    s_add_u32 s34, s34, s38
    s_add_u32 m0, s37, 101376
    s_nop 0
    buffer_load_dwordx4 v11, s[4:7], s34 offen lds
    s_waitcnt vmcnt(24)
    s_barrier
    s_add_u32 s34, s31, 1605632
    s_add_u32 s34, s34, s38
    s_add_u32 m0, s37, 114688
    s_nop 0
    buffer_load_dwordx4 v10, s[4:7], s34 offen lds
    s_add_u32 s34, s31, 1619968
    s_add_u32 s34, s34, s38
    s_add_u32 m0, s37, 115712
    s_nop 0
    buffer_load_dwordx4 v11, s[4:7], s34 offen lds
    s_add_u32 s34, s31, 1634304
    s_add_u32 s34, s34, s38
    s_add_u32 m0, s37, 116736
    s_nop 0
    buffer_load_dwordx4 v10, s[4:7], s34 offen lds
    s_add_u32 s34, s31, 1648640
    s_add_u32 s34, s34, s38
    s_add_u32 m0, s37, 117760
    s_nop 0
    buffer_load_dwordx4 v11, s[4:7], s34 offen lds
    s_lshl_b32 s34, s25, 6
    s_add_u32 s34, s34, 0
    v_xor_b32 v13, s34, v12
    v_add_u32 v13, 0, v13
    ds_read_b64_tr_b16 a[0:1], v13 offset:0
    ds_read_b64_tr_b16 a[2:3], v13 offset:4096
    ds_read_b64_tr_b16 a[8:9], v13 offset:8192
    ds_read_b64_tr_b16 a[10:11], v13 offset:12288
    s_lshl_b32 s34, s25, 6
    s_add_u32 s34, s34, 32
    v_xor_b32 v13, s34, v12
    v_add_u32 v13, 0, v13
    ds_read_b64_tr_b16 a[4:5], v13 offset:0
    ds_read_b64_tr_b16 a[6:7], v13 offset:4096
    ds_read_b64_tr_b16 a[12:13], v13 offset:8192
    ds_read_b64_tr_b16 a[14:15], v13 offset:12288
    s_waitcnt lgkmcnt(0)
    s_waitcnt vmcnt(24)
    s_barrier
    s_lshl_b32 s34, s25, 6
    s_add_u32 s34, s34, 0
    v_xor_b32 v13, s34, v12
    v_add_u32 v13, 16384, v13
    ds_read_b64_tr_b16 a[16:17], v13 offset:0
    ds_read_b64_tr_b16 a[18:19], v13 offset:4096
    ds_read_b64_tr_b16 a[24:25], v13 offset:8192
    ds_read_b64_tr_b16 a[26:27], v13 offset:12288
    s_lshl_b32 s34, s25, 6
    s_add_u32 s34, s34, 32
    v_xor_b32 v13, s34, v12
    v_add_u32 v13, 16384, v13
    ds_read_b64_tr_b16 a[20:21], v13 offset:0
    ds_read_b64_tr_b16 a[22:23], v13 offset:4096
    ds_read_b64_tr_b16 a[28:29], v13 offset:8192
    ds_read_b64_tr_b16 a[30:31], v13 offset:12288
    s_waitcnt lgkmcnt(0)
    s_waitcnt vmcnt(20)
    s_barrier
    s_lshl_b32 s34, s25, 6
    s_add_u32 s34, s34, 0
    v_xor_b32 v13, s34, v12
    v_add_u32 v13, 32768, v13
    ds_read_b64_tr_b16 a[32:33], v13 offset:0
    ds_read_b64_tr_b16 a[34:35], v13 offset:4096
    ds_read_b64_tr_b16 a[40:41], v13 offset:8192
    ds_read_b64_tr_b16 a[42:43], v13 offset:12288
    s_lshl_b32 s34, s25, 6
    s_add_u32 s34, s34, 32
    v_xor_b32 v13, s34, v12
    v_add_u32 v13, 32768, v13
    ds_read_b64_tr_b16 a[36:37], v13 offset:0
    ds_read_b64_tr_b16 a[38:39], v13 offset:4096
    ds_read_b64_tr_b16 a[44:45], v13 offset:8192
    ds_read_b64_tr_b16 a[46:47], v13 offset:12288
    s_waitcnt lgkmcnt(0)
    s_waitcnt vmcnt(16)
    s_barrier
    s_lshl_b32 s34, s25, 6
    s_add_u32 s34, s34, 0
    v_xor_b32 v13, s34, v12
    v_add_u32 v13, 49152, v13
    ds_read_b64_tr_b16 a[48:49], v13 offset:0
    ds_read_b64_tr_b16 a[50:51], v13 offset:4096
    ds_read_b64_tr_b16 a[56:57], v13 offset:8192
    ds_read_b64_tr_b16 a[58:59], v13 offset:12288
    s_lshl_b32 s34, s25, 6
    s_add_u32 s34, s34, 32
    v_xor_b32 v13, s34, v12
    v_add_u32 v13, 49152, v13
    ds_read_b64_tr_b16 a[52:53], v13 offset:0
    ds_read_b64_tr_b16 a[54:55], v13 offset:4096
    ds_read_b64_tr_b16 a[60:61], v13 offset:8192
    ds_read_b64_tr_b16 a[62:63], v13 offset:12288
    s_waitcnt lgkmcnt(0)
    s_waitcnt vmcnt(12)
    s_barrier
    s_lshl_b32 s34, s25, 6
    s_add_u32 s34, s34, 0
    v_xor_b32 v13, s34, v12
    v_add_u32 v13, 65536, v13
    ds_read_b64_tr_b16 a[64:65], v13 offset:0
    ds_read_b64_tr_b16 a[66:67], v13 offset:4096
    ds_read_b64_tr_b16 a[72:73], v13 offset:8192
    ds_read_b64_tr_b16 a[74:75], v13 offset:12288
    s_lshl_b32 s34, s25, 6
    s_add_u32 s34, s34, 32
    v_xor_b32 v13, s34, v12
    v_add_u32 v13, 65536, v13
    ds_read_b64_tr_b16 a[68:69], v13 offset:0
    ds_read_b64_tr_b16 a[70:71], v13 offset:4096
    ds_read_b64_tr_b16 a[76:77], v13 offset:8192
    ds_read_b64_tr_b16 a[78:79], v13 offset:12288
    s_waitcnt lgkmcnt(0)
    s_waitcnt vmcnt(8)
    s_barrier
    s_lshl_b32 s34, s25, 6
    s_add_u32 s34, s34, 0
    v_xor_b32 v13, s34, v12
    v_add_u32 v13, 81920, v13
    ds_read_b64_tr_b16 a[80:81], v13 offset:0
    ds_read_b64_tr_b16 a[82:83], v13 offset:4096
    ds_read_b64_tr_b16 a[88:89], v13 offset:8192
    ds_read_b64_tr_b16 a[90:91], v13 offset:12288
    s_lshl_b32 s34, s25, 6
    s_add_u32 s34, s34, 32
    v_xor_b32 v13, s34, v12
    v_add_u32 v13, 81920, v13
    ds_read_b64_tr_b16 a[84:85], v13 offset:0
    ds_read_b64_tr_b16 a[86:87], v13 offset:4096
    ds_read_b64_tr_b16 a[92:93], v13 offset:8192
    ds_read_b64_tr_b16 a[94:95], v13 offset:12288
    s_waitcnt lgkmcnt(0)
    s_waitcnt vmcnt(4)
    s_barrier
    s_lshl_b32 s34, s25, 6
    s_add_u32 s34, s34, 0
    v_xor_b32 v13, s34, v12
    v_add_u32 v13, 98304, v13
    ds_read_b64_tr_b16 a[96:97], v13 offset:0
    ds_read_b64_tr_b16 a[98:99], v13 offset:4096
    ds_read_b64_tr_b16 a[104:105], v13 offset:8192
    ds_read_b64_tr_b16 a[106:107], v13 offset:12288
    s_lshl_b32 s34, s25, 6
    s_add_u32 s34, s34, 32
    v_xor_b32 v13, s34, v12
    v_add_u32 v13, 98304, v13
    ds_read_b64_tr_b16 a[100:101], v13 offset:0
    ds_read_b64_tr_b16 a[102:103], v13 offset:4096
    ds_read_b64_tr_b16 a[108:109], v13 offset:8192
    ds_read_b64_tr_b16 a[110:111], v13 offset:12288
    s_waitcnt lgkmcnt(0)
    s_waitcnt vmcnt(0)
    s_barrier
    s_lshl_b32 s34, s25, 6
    s_add_u32 s34, s34, 0
    v_xor_b32 v13, s34, v12
    v_add_u32 v13, 114688, v13
    ds_read_b64_tr_b16 a[112:113], v13 offset:0
    ds_read_b64_tr_b16 a[114:115], v13 offset:4096
    ds_read_b64_tr_b16 a[120:121], v13 offset:8192
    ds_read_b64_tr_b16 a[122:123], v13 offset:12288
    s_lshl_b32 s34, s25, 6
    s_add_u32 s34, s34, 32
    v_xor_b32 v13, s34, v12
    v_add_u32 v13, 114688, v13
    ds_read_b64_tr_b16 a[116:117], v13 offset:0
    ds_read_b64_tr_b16 a[118:119], v13 offset:4096
    ds_read_b64_tr_b16 a[124:125], v13 offset:8192
    ds_read_b64_tr_b16 a[126:127], v13 offset:12288
    s_waitcnt lgkmcnt(0)
    s_mov_b32 s26, s29
    s_mov_b32 s27, 0
    s_barrier
    s_lshl_b32 s34, s26, 15
    s_lshl_b32 s35, s25, 13
    s_add_u32 s34, s34, s35
    s_add_u32 s35, s35, s27
    s_mov_b32 m0, s35
    s_nop 0
    buffer_load_dwordx4 v1, s[8:11], s34 offen offset:0 sc1 lds
    buffer_load_dwordx4 v1, s[8:11], s34 offen offset:1024 sc1 lds
    buffer_load_dwordx4 v1, s[8:11], s34 offen offset:2048 sc1 lds
    buffer_load_dwordx4 v1, s[8:11], s34 offen offset:3072 sc1 lds
    s_add_u32 m0, s35, 4096
    s_add_u32 s34, s34, 4096
    buffer_load_dwordx4 v1, s[8:11], s34 offen offset:0 sc1 lds
    buffer_load_dwordx4 v1, s[8:11], s34 offen offset:1024 sc1 lds
    buffer_load_dwordx4 v1, s[8:11], s34 offen offset:2048 sc1 lds
    buffer_load_dwordx4 v1, s[8:11], s34 offen offset:3072 sc1 lds
    s_waitcnt vmcnt(0)
    s_barrier
F1_loop:
    s_add_u32 s48, s26, 16
    s_xor_b32 s32, s27, 32768
    s_cmp_ge_u32 s48, 64
    s_cbranch_scc1 F1_nopf
    s_lshl_b32 s34, s48, 15
    s_lshl_b32 s35, s25, 13
    s_add_u32 s34, s34, s35
    s_add_u32 s35, s35, s32
    s_mov_b32 m0, s35
    s_nop 0
    buffer_load_dwordx4 v1, s[8:11], s34 offen offset:0 sc1 lds
    buffer_load_dwordx4 v1, s[8:11], s34 offen offset:1024 sc1 lds
    buffer_load_dwordx4 v1, s[8:11], s34 offen offset:2048 sc1 lds
    buffer_load_dwordx4 v1, s[8:11], s34 offen offset:3072 sc1 lds
    s_add_u32 m0, s35, 4096
    s_add_u32 s34, s34, 4096
    buffer_load_dwordx4 v1, s[8:11], s34 offen offset:0 sc1 lds
    buffer_load_dwordx4 v1, s[8:11], s34 offen offset:1024 sc1 lds
    buffer_load_dwordx4 v1, s[8:11], s34 offen offset:2048 sc1 lds
    buffer_load_dwordx4 v1, s[8:11], s34 offen offset:3072 sc1 lds
F1_nopf:
    v_add_u32 v8, s27, v1
    ds_read_b128 v[16:19], v8 offset:0
    ds_read_b128 v[20:23], v8 offset:16384
    ds_read_b128 v[24:27], v8 offset:1024
    ds_read_b128 v[28:31], v8 offset:17408
    s_waitcnt lgkmcnt(3)
    v_mfma_f32_16x16x32_bf16 v[40:43], a[0:3], v[16:19], 0
    ds_read_b128 v[32:35], v8 offset:2048
    v_mfma_f32_16x16x32_bf16 v[44:47], a[4:7], v[16:19], 0
    ds_read_b128 v[36:39], v8 offset:18432
    s_waitcnt lgkmcnt(4)
    v_mfma_f32_16x16x32_bf16 v[48:51], a[0:3], v[20:23], 0
    v_mfma_f32_16x16x32_bf16 v[52:55], a[4:7], v[20:23], 0
    s_waitcnt lgkmcnt(3)
    v_mfma_f32_16x16x32_bf16 v[40:43], a[8:11], v[24:27], v[40:43]
    ds_read_b128 v[16:19], v8 offset:3072
    v_mfma_f32_16x16x32_bf16 v[44:47], a[12:15], v[24:27], v[44:47]
    ds_read_b128 v[20:23], v8 offset:19456
    s_waitcnt lgkmcnt(4)
    v_mfma_f32_16x16x32_bf16 v[48:51], a[8:11], v[28:31], v[48:51]
    v_mfma_f32_16x16x32_bf16 v[52:55], a[12:15], v[28:31], v[52:55]
    s_waitcnt lgkmcnt(3)
    v_mfma_f32_16x16x32_bf16 v[40:43], a[16:19], v[32:35], v[40:43]
    ds_read_b128 v[24:27], v8 offset:4096
    v_mfma_f32_16x16x32_bf16 v[44:47], a[20:23], v[32:35], v[44:47]
    ds_read_b128 v[28:31], v8 offset:20480
    s_waitcnt lgkmcnt(4)
    v_mfma_f32_16x16x32_bf16 v[48:51], a[16:19], v[36:39], v[48:51]
    v_mfma_f32_16x16x32_bf16 v[52:55], a[20:23], v[36:39], v[52:55]
    s_waitcnt lgkmcnt(3)
    v_mfma_f32_16x16x32_bf16 v[40:43], a[24:27], v[16:19], v[40:43]
    ds_read_b128 v[32:35], v8 offset:5120
    v_mfma_f32_16x16x32_bf16 v[44:47], a[28:31], v[16:19], v[44:47]
    ds_read_b128 v[36:39], v8 offset:21504
    s_waitcnt lgkmcnt(4)
    v_mfma_f32_16x16x32_bf16 v[48:51], a[24:27], v[20:23], v[48:51]
    v_mfma_f32_16x16x32_bf16 v[52:55], a[28:31], v[20:23], v[52:55]
    s_waitcnt lgkmcnt(3)
    v_mfma_f32_16x16x32_bf16 v[40:43], a[32:35], v[24:27], v[40:43]
    ds_read_b128 v[16:19], v8 offset:6144
    v_mfma_f32_16x16x32_bf16 v[44:47], a[36:39], v[24:27], v[44:47]
    ds_read_b128 v[20:23], v8 offset:22528
    s_waitcnt lgkmcnt(4)
    v_mfma_f32_16x16x32_bf16 v[48:51], a[32:35], v[28:31], v[48:51]
    v_mfma_f32_16x16x32_bf16 v[52:55], a[36:39], v[28:31], v[52:55]
    s_waitcnt lgkmcnt(3)
    v_mfma_f32_16x16x32_bf16 v[40:43], a[40:43], v[32:35], v[40:43]
    ds_read_b128 v[24:27], v8 offset:7168
    v_mfma_f32_16x16x32_bf16 v[44:47], a[44:47], v[32:35], v[44:47]
    ds_read_b128 v[28:31], v8 offset:23552
    s_waitcnt lgkmcnt(4)
    v_mfma_f32_16x16x32_bf16 v[48:51], a[40:43], v[36:39], v[48:51]
    v_mfma_f32_16x16x32_bf16 v[52:55], a[44:47], v[36:39], v[52:55]
    s_waitcnt lgkmcnt(3)
    v_mfma_f32_16x16x32_bf16 v[40:43], a[48:51], v[16:19], v[40:43]
    ds_read_b128 v[32:35], v8 offset:8192
    v_mfma_f32_16x16x32_bf16 v[44:47], a[52:55], v[16:19], v[44:47]
    ds_read_b128 v[36:39], v8 offset:24576
    s_waitcnt lgkmcnt(4)
    v_mfma_f32_16x16x32_bf16 v[48:51], a[48:51], v[20:23], v[48:51]
    v_mfma_f32_16x16x32_bf16 v[52:55], a[52:55], v[20:23], v[52:55]
    s_waitcnt lgkmcnt(3)
    v_mfma_f32_16x16x32_bf16 v[40:43], a[56:59], v[24:27], v[40:43]
    ds_read_b128 v[16:19], v8 offset:9216
    v_mfma_f32_16x16x32_bf16 v[44:47], a[60:63], v[24:27], v[44:47]
    ds_read_b128 v[20:23], v8 offset:25600
    s_waitcnt lgkmcnt(4)
    v_mfma_f32_16x16x32_bf16 v[48:51], a[56:59], v[28:31], v[48:51]
    v_mfma_f32_16x16x32_bf16 v[52:55], a[60:63], v[28:31], v[52:55]
    s_waitcnt lgkmcnt(3)
    v_mfma_f32_16x16x32_bf16 v[40:43], a[64:67], v[32:35], v[40:43]
    ds_read_b128 v[24:27], v8 offset:10240
    v_mfma_f32_16x16x32_bf16 v[44:47], a[68:71], v[32:35], v[44:47]
    ds_read_b128 v[28:31], v8 offset:26624
    s_waitcnt lgkmcnt(4)
    v_mfma_f32_16x16x32_bf16 v[48:51], a[64:67], v[36:39], v[48:51]
    v_mfma_f32_16x16x32_bf16 v[52:55], a[68:71], v[36:39], v[52:55]
    s_waitcnt lgkmcnt(3)
    v_mfma_f32_16x16x32_bf16 v[40:43], a[72:75], v[16:19], v[40:43]
    ds_read_b128 v[32:35], v8 offset:11264
    v_mfma_f32_16x16x32_bf16 v[44:47], a[76:79], v[16:19], v[44:47]
    ds_read_b128 v[36:39], v8 offset:27648
    s_waitcnt lgkmcnt(4)
    v_mfma_f32_16x16x32_bf16 v[48:51], a[72:75], v[20:23], v[48:51]
    v_mfma_f32_16x16x32_bf16 v[52:55], a[76:79], v[20:23], v[52:55]
    s_waitcnt lgkmcnt(3)
    v_mfma_f32_16x16x32_bf16 v[40:43], a[80:83], v[24:27], v[40:43]
    ds_read_b128 v[16:19], v8 offset:12288
    v_mfma_f32_16x16x32_bf16 v[44:47], a[84:87], v[24:27], v[44:47]
    ds_read_b128 v[20:23], v8 offset:28672
    s_waitcnt lgkmcnt(4)
    v_mfma_f32_16x16x32_bf16 v[48:51], a[80:83], v[28:31], v[48:51]
    v_mfma_f32_16x16x32_bf16 v[52:55], a[84:87], v[28:31], v[52:55]
    s_waitcnt lgkmcnt(3)
    v_mfma_f32_16x16x32_bf16 v[40:43], a[88:91], v[32:35], v[40:43]
    ds_read_b128 v[24:27], v8 offset:13312
    v_mfma_f32_16x16x32_bf16 v[44:47], a[92:95], v[32:35], v[44:47]
    ds_read_b128 v[28:31], v8 offset:29696
    s_waitcnt lgkmcnt(4)
    v_mfma_f32_16x16x32_bf16 v[48:51], a[88:91], v[36:39], v[48:51]
    v_mfma_f32_16x16x32_bf16 v[52:55], a[92:95], v[36:39], v[52:55]
    s_waitcnt lgkmcnt(3)
    v_mfma_f32_16x16x32_bf16 v[40:43], a[96:99], v[16:19], v[40:43]
    ds_read_b128 v[32:35], v8 offset:14336
    v_mfma_f32_16x16x32_bf16 v[44:47], a[100:103], v[16:19], v[44:47]
    ds_read_b128 v[36:39], v8 offset:30720
    s_waitcnt lgkmcnt(4)
    v_mfma_f32_16x16x32_bf16 v[48:51], a[96:99], v[20:23], v[48:51]
    v_mfma_f32_16x16x32_bf16 v[52:55], a[100:103], v[20:23], v[52:55]
    s_waitcnt lgkmcnt(3)
    v_mfma_f32_16x16x32_bf16 v[40:43], a[104:107], v[24:27], v[40:43]
    ds_read_b128 v[16:19], v8 offset:15360
    v_mfma_f32_16x16x32_bf16 v[44:47], a[108:111], v[24:27], v[44:47]
    ds_read_b128 v[20:23], v8 offset:31744
    s_waitcnt lgkmcnt(4)
    v_mfma_f32_16x16x32_bf16 v[48:51], a[104:107], v[28:31], v[48:51]
    v_mfma_f32_16x16x32_bf16 v[52:55], a[108:111], v[28:31], v[52:55]
    s_waitcnt lgkmcnt(3)
    v_mfma_f32_16x16x32_bf16 v[40:43], a[112:115], v[32:35], v[40:43]
    v_mfma_f32_16x16x32_bf16 v[44:47], a[116:119], v[32:35], v[44:47]
    s_waitcnt lgkmcnt(2)
    v_mfma_f32_16x16x32_bf16 v[48:51], a[112:115], v[36:39], v[48:51]
    v_mfma_f32_16x16x32_bf16 v[52:55], a[116:119], v[36:39], v[52:55]
    s_waitcnt lgkmcnt(1)
    v_mfma_f32_16x16x32_bf16 v[40:43], a[120:123], v[16:19], v[40:43]
    v_mfma_f32_16x16x32_bf16 v[44:47], a[124:127], v[16:19], v[44:47]
    s_waitcnt lgkmcnt(0)
    v_mfma_f32_16x16x32_bf16 v[48:51], a[120:123], v[20:23], v[48:51]
    v_mfma_f32_16x16x32_bf16 v[52:55], a[124:127], v[20:23], v[52:55]
    s_mov_b32 s35, 0x3fb8aa3b
    s_mov_b32 s36, 0x41a00000
    v_add_f32 v40, v40, v72
    v_add_f32 v41, v41, v73
    v_add_f32 v42, v42, v74
    v_add_f32 v43, v43, v75
    v_add_f32 v44, v44, v76
    v_add_f32 v45, v45, v77
    v_add_f32 v46, v46, v78
    v_add_f32 v47, v47, v79
    v_min_f32 v84, s36, v40
    v_mul_f32 v84, s35, v84
    v_min_f32 v85, s36, v41
    v_mul_f32 v85, s35, v85
    v_min_f32 v86, s36, v42
    v_mul_f32 v86, s35, v86
    v_min_f32 v87, s36, v43
    v_mul_f32 v87, s35, v87
    v_min_f32 v88, s36, v44
    v_mul_f32 v88, s35, v88
    v_min_f32 v89, s36, v45
    v_mul_f32 v89, s35, v89
    v_min_f32 v90, s36, v46
    v_mul_f32 v90, s35, v90
    v_min_f32 v91, s36, v47
    v_mul_f32 v91, s35, v91
    v_exp_f32 v84, v84
    v_exp_f32 v85, v85
    v_exp_f32 v86, v86
    v_exp_f32 v87, v87
    v_exp_f32 v88, v88
    v_exp_f32 v89, v89
    v_exp_f32 v90, v90
    v_exp_f32 v91, v91
    v_add_f32 v92, 2.0, v84
    v_mul_f32 v84, v84, v92
    v_add_f32 v93, 2.0, v85
    v_mul_f32 v85, v85, v93
    v_add_f32 v94, 2.0, v86
    v_mul_f32 v86, v86, v94
    v_add_f32 v95, 2.0, v87
    v_mul_f32 v87, v87, v95
    v_add_f32 v96, 2.0, v88
    v_mul_f32 v88, v88, v96
    v_add_f32 v97, 2.0, v89
    v_mul_f32 v89, v89, v97
    v_add_f32 v98, 2.0, v90
    v_mul_f32 v90, v90, v98
    v_add_f32 v99, 2.0, v91
    v_mul_f32 v91, v91, v99
    v_add_f32 v92, 2.0, v84
    v_add_f32 v93, 2.0, v85
    v_add_f32 v94, 2.0, v86
    v_add_f32 v95, 2.0, v87
    v_add_f32 v96, 2.0, v88
    v_add_f32 v97, 2.0, v89
    v_add_f32 v98, 2.0, v90
    v_add_f32 v99, 2.0, v91
    v_rcp_f32 v92, v92
    v_rcp_f32 v93, v93
    v_rcp_f32 v94, v94
    v_rcp_f32 v95, v95
    v_rcp_f32 v96, v96
    v_rcp_f32 v97, v97
    v_rcp_f32 v98, v98
    v_rcp_f32 v99, v99
    v_mul_f32 v84, v84, v92
    v_mul_f32 v40, v40, v84
    v_mul_f32 v85, v85, v93
    v_mul_f32 v41, v41, v85
    v_mul_f32 v86, v86, v94
    v_mul_f32 v42, v42, v86
    v_mul_f32 v87, v87, v95
    v_mul_f32 v43, v43, v87
    v_mul_f32 v88, v88, v96
    v_mul_f32 v44, v44, v88
    v_mul_f32 v89, v89, v97
    v_mul_f32 v45, v45, v89
    v_mul_f32 v90, v90, v98
    v_mul_f32 v46, v46, v90
    v_mul_f32 v91, v91, v99
    v_mul_f32 v47, v47, v91
    v_cvt_pk_bf16_f32 v100, v40, v41
    v_cvt_pk_bf16_f32 v101, v42, v43
    v_cvt_pk_bf16_f32 v102, v44, v45
    v_cvt_pk_bf16_f32 v103, v46, v47
    v_add_f32 v48, v48, v72
    v_add_f32 v49, v49, v73
    v_add_f32 v50, v50, v74
    v_add_f32 v51, v51, v75
    v_add_f32 v52, v52, v76
    v_add_f32 v53, v53, v77
    v_add_f32 v54, v54, v78
    v_add_f32 v55, v55, v79
    v_min_f32 v84, s36, v48
    v_mul_f32 v84, s35, v84
    v_min_f32 v85, s36, v49
    v_mul_f32 v85, s35, v85
    v_min_f32 v86, s36, v50
    v_mul_f32 v86, s35, v86
    v_min_f32 v87, s36, v51
    v_mul_f32 v87, s35, v87
    v_min_f32 v88, s36, v52
    v_mul_f32 v88, s35, v88
    v_min_f32 v89, s36, v53
    v_mul_f32 v89, s35, v89
    v_min_f32 v90, s36, v54
    v_mul_f32 v90, s35, v90
    v_min_f32 v91, s36, v55
    v_mul_f32 v91, s35, v91
    v_exp_f32 v84, v84
    v_exp_f32 v85, v85
    v_exp_f32 v86, v86
    v_exp_f32 v87, v87
    v_exp_f32 v88, v88
    v_exp_f32 v89, v89
    v_exp_f32 v90, v90
    v_exp_f32 v91, v91
    v_add_f32 v92, 2.0, v84
    v_mul_f32 v84, v84, v92
    v_add_f32 v93, 2.0, v85
    v_mul_f32 v85, v85, v93
    v_add_f32 v94, 2.0, v86
    v_mul_f32 v86, v86, v94
    v_add_f32 v95, 2.0, v87
    v_mul_f32 v87, v87, v95
    v_add_f32 v96, 2.0, v88
    v_mul_f32 v88, v88, v96
    v_add_f32 v97, 2.0, v89
    v_mul_f32 v89, v89, v97
    v_add_f32 v98, 2.0, v90
    v_mul_f32 v90, v90, v98
    v_add_f32 v99, 2.0, v91
    v_mul_f32 v91, v91, v99
    v_add_f32 v92, 2.0, v84
    v_add_f32 v93, 2.0, v85
    v_add_f32 v94, 2.0, v86
    v_add_f32 v95, 2.0, v87
    v_add_f32 v96, 2.0, v88
    v_add_f32 v97, 2.0, v89
    v_add_f32 v98, 2.0, v90
    v_add_f32 v99, 2.0, v91
    v_rcp_f32 v92, v92
    v_rcp_f32 v93, v93
    v_rcp_f32 v94, v94
    v_rcp_f32 v95, v95
    v_rcp_f32 v96, v96
    v_rcp_f32 v97, v97
    v_rcp_f32 v98, v98
    v_rcp_f32 v99, v99
    v_mul_f32 v84, v84, v92
    v_mul_f32 v48, v48, v84
    v_mul_f32 v85, v85, v93
    v_mul_f32 v49, v49, v85
    v_mul_f32 v86, v86, v94
    v_mul_f32 v50, v50, v86
    v_mul_f32 v87, v87, v95
    v_mul_f32 v51, v51, v87
    v_mul_f32 v88, v88, v96
    v_mul_f32 v52, v52, v88
    v_mul_f32 v89, v89, v97
    v_mul_f32 v53, v53, v89
    v_mul_f32 v90, v90, v98
    v_mul_f32 v54, v54, v90
    v_mul_f32 v91, v91, v99
    v_mul_f32 v55, v55, v91
    v_cvt_pk_bf16_f32 v104, v48, v49
    v_cvt_pk_bf16_f32 v105, v50, v51
    v_cvt_pk_bf16_f32 v106, v52, v53
    v_cvt_pk_bf16_f32 v107, v54, v55
    s_mul_i32 s34, s26, 114688
    s_lshl_b32 s35, s28, 2
    s_add_u32 s35, s35, s25
    s_lshl_b32 s35, s35, 10
    s_add_u32 s34, s34, s35
    buffer_store_dwordx4 v[100:103], v1, s[16:19], s34 offen sc1
    s_add_u32 s34, s34, 57344
    buffer_store_dwordx4 v[104:107], v1, s[16:19], s34 offen sc1
    s_waitcnt vmcnt(2)
    s_barrier
    s_mov_b32 s26, s48
    s_mov_b32 s27, s32
    s_cmp_lt_u32 s26, 64
    s_cbranch_scc1 F1_loop
    s_waitcnt vmcnt(0)
    s_barrier
    s_cmp_lg_u32 s25, 0
    s_cbranch_scc1 F1_f1_noarr
    v_mov_b32 v8, 1
    s_mov_b32 s34, 384
    s_mov_b64 exec, 1
    buffer_atomic_add v8, v7, s[40:43], s34 offen
    s_mov_b64 exec, -1
F1_f1_noarr:
    s_cmp_ge_u32 s24, 64
    s_cbranch_scc1 L_final
    s_and_b32 s28, s24, 31
    s_lshr_b32 s29, s24, 5
    s_lshl_b32 s31, s28, 8
    s_load_dwordx2 s[46:47], s[0:1], 16
    s_waitcnt lgkmcnt(0)
    s_mov_b32 s4, s46
    s_mov_b32 s5, s47
    s_mov_b32 s6, 4194304
    s_mov_b32 s7, 0x20000
    v_lshrrev_b32 v14, 4, v3
    s_mov_b32 s34, 8192
    v_mul_lo_u32 v10, v14, s34
    v_lshlrev_b32 v14, 1, v14
    v_xor_b32 v14, v14, v4
    v_lshl_add_u32 v10, v14, 4, v10
    v_xor_b32 v11, 0x80, v10
    v_bfe_u32 v14, v3, 2, 2
    v_lshl_add_u32 v15, v5, 2, v14
    v_lshlrev_b32 v12, 8, v15
    v_lshlrev_b32 v14, 1, v14
    v_and_b32 v15, 1, v5
    v_lshl_add_u32 v14, v15, 3, v14
    v_bfe_u32 v15, v3, 1, 1
    v_xor_b32 v14, v14, v15
    v_lshl_add_u32 v12, v14, 4, v12
    v_and_b32 v15, 1, v3
    v_lshl_add_u32 v12, v15, 3, v12
    s_mul_i32 s38, s25, 131072
    s_lshl_b32 s37, s25, 12
    s_waitcnt vmcnt(0) lgkmcnt(0)
    s_barrier
    s_add_u32 s34, s31, 0
    s_add_u32 s34, s34, s38
    s_add_u32 m0, s37, 0
    s_nop 0
    buffer_load_dwordx4 v10, s[4:7], s34 offen lds
    s_add_u32 s34, s31, 32768
    s_add_u32 s34, s34, s38
    s_add_u32 m0, s37, 1024
    s_nop 0
    buffer_load_dwordx4 v11, s[4:7], s34 offen lds
    s_add_u32 s34, s31, 65536
    s_add_u32 s34, s34, s38
    s_add_u32 m0, s37, 2048
    s_nop 0
    buffer_load_dwordx4 v10, s[4:7], s34 offen lds
    s_add_u32 s34, s31, 98304
    s_add_u32 s34, s34, s38
    s_add_u32 m0, s37, 3072
    s_nop 0
    buffer_load_dwordx4 v11, s[4:7], s34 offen lds
    s_add_u32 s34, s31, 524288
    s_add_u32 s34, s34, s38
    s_add_u32 m0, s37, 16384
    s_nop 0
    buffer_load_dwordx4 v10, s[4:7], s34 offen lds
    s_add_u32 s34, s31, 557056
    s_add_u32 s34, s34, s38
    s_add_u32 m0, s37, 17408
    s_nop 0
    buffer_load_dwordx4 v11, s[4:7], s34 offen lds
    s_add_u32 s34, s31, 589824
    s_add_u32 s34, s34, s38
    s_add_u32 m0, s37, 18432
    s_nop 0
    buffer_load_dwordx4 v10, s[4:7], s34 offen lds
    s_add_u32 s34, s31, 622592
    s_add_u32 s34, s34, s38
    s_add_u32 m0, s37, 19456
    s_nop 0
    buffer_load_dwordx4 v11, s[4:7], s34 offen lds
    s_add_u32 s34, s31, 1048576
    s_add_u32 s34, s34, s38
    s_add_u32 m0, s37, 32768
    s_nop 0
    buffer_load_dwordx4 v10, s[4:7], s34 offen lds
    s_add_u32 s34, s31, 1081344
    s_add_u32 s34, s34, s38
    s_add_u32 m0, s37, 33792
    s_nop 0
    buffer_load_dwordx4 v11, s[4:7], s34 offen lds
    s_add_u32 s34, s31, 1114112
    s_add_u32 s34, s34, s38
    s_add_u32 m0, s37, 34816
    s_nop 0
    buffer_load_dwordx4 v10, s[4:7], s34 offen lds
    s_add_u32 s34, s31, 1146880
    s_add_u32 s34, s34, s38
    s_add_u32 m0, s37, 35840
    s_nop 0
    buffer_load_dwordx4 v11, s[4:7], s34 offen lds
    s_add_u32 s34, s31, 1572864
    s_add_u32 s34, s34, s38
    s_add_u32 m0, s37, 49152
    s_nop 0
    buffer_load_dwordx4 v10, s[4:7], s34 offen lds
    s_add_u32 s34, s31, 1605632
    s_add_u32 s34, s34, s38
    s_add_u32 m0, s37, 50176
    s_nop 0
    buffer_load_dwordx4 v11, s[4:7], s34 offen lds
    s_add_u32 s34, s31, 1638400
    s_add_u32 s34, s34, s38
    s_add_u32 m0, s37, 51200
    s_nop 0
    buffer_load_dwordx4 v10, s[4:7], s34 offen lds
    s_add_u32 s34, s31, 1671168
    s_add_u32 s34, s34, s38
    s_add_u32 m0, s37, 52224
    s_nop 0
    buffer_load_dwordx4 v11, s[4:7], s34 offen lds
    s_add_u32 s34, s31, 2097152
    s_add_u32 s34, s34, s38
    s_add_u32 m0, s37, 65536
    s_nop 0
    buffer_load_dwordx4 v10, s[4:7], s34 offen lds
    s_add_u32 s34, s31, 2129920
    s_add_u32 s34, s34, s38
    s_add_u32 m0, s37, 66560
    s_nop 0
    buffer_load_dwordx4 v11, s[4:7], s34 offen lds
    s_add_u32 s34, s31, 2162688
    s_add_u32 s34, s34, s38
    s_add_u32 m0, s37, 67584
    s_nop 0
    buffer_load_dwordx4 v10, s[4:7], s34 offen lds
    s_add_u32 s34, s31, 2195456
    s_add_u32 s34, s34, s38
    s_add_u32 m0, s37, 68608
    s_nop 0
    buffer_load_dwordx4 v11, s[4:7], s34 offen lds
    s_add_u32 s34, s31, 2621440
    s_add_u32 s34, s34, s38
    s_add_u32 m0, s37, 81920
    s_nop 0
    buffer_load_dwordx4 v10, s[4:7], s34 offen lds
    s_add_u32 s34, s31, 2654208
    s_add_u32 s34, s34, s38
    s_add_u32 m0, s37, 82944
    s_nop 0
    buffer_load_dwordx4 v11, s[4:7], s34 offen lds
    s_add_u32 s34, s31, 2686976
    s_add_u32 s34, s34, s38
    s_add_u32 m0, s37, 83968
    s_nop 0
    buffer_load_dwordx4 v10, s[4:7], s34 offen lds
    s_add_u32 s34, s31, 2719744
    s_add_u32 s34, s34, s38
    s_add_u32 m0, s37, 84992
    s_nop 0
    buffer_load_dwordx4 v11, s[4:7], s34 offen lds
    s_add_u32 s34, s31, 3145728
    s_add_u32 s34, s34, s38
    s_add_u32 m0, s37, 98304
    s_nop 0
    buffer_load_dwordx4 v10, s[4:7], s34 offen lds
    s_add_u32 s34, s31, 3178496
    s_add_u32 s34, s34, s38
    s_add_u32 m0, s37, 99328
    s_nop 0
    buffer_load_dwordx4 v11, s[4:7], s34 offen lds
    s_add_u32 s34, s31, 3211264
    s_add_u32 s34, s34, s38
    s_add_u32 m0, s37, 100352
    s_nop 0
    buffer_load_dwordx4 v10, s[4:7], s34 offen lds
    s_add_u32 s34, s31, 3244032
    s_add_u32 s34, s34, s38
    s_add_u32 m0, s37, 101376
    s_nop 0
    buffer_load_dwordx4 v11, s[4:7], s34 offen lds
    s_waitcnt vmcnt(24)
    s_barrier
    s_add_u32 s34, s31, 3670016
    s_add_u32 s34, s34, s38
    s_add_u32 m0, s37, 114688
    s_nop 0
    buffer_load_dwordx4 v10, s[4:7], s34 offen lds
    s_add_u32 s34, s31, 3702784
    s_add_u32 s34, s34, s38
    s_add_u32 m0, s37, 115712
    s_nop 0
    buffer_load_dwordx4 v11, s[4:7], s34 offen lds
    s_add_u32 s34, s31, 3735552
    s_add_u32 s34, s34, s38
    s_add_u32 m0, s37, 116736
    s_nop 0
    buffer_load_dwordx4 v10, s[4:7], s34 offen lds
    s_add_u32 s34, s31, 3768320
    s_add_u32 s34, s34, s38
    s_add_u32 m0, s37, 117760
    s_nop 0
    buffer_load_dwordx4 v11, s[4:7], s34 offen lds
    s_lshl_b32 s34, s25, 6
    s_add_u32 s34, s34, 0
    v_xor_b32 v13, s34, v12
    v_add_u32 v13, 0, v13
    ds_read_b64_tr_b16 a[0:1], v13 offset:0
    ds_read_b64_tr_b16 a[2:3], v13 offset:4096
    ds_read_b64_tr_b16 a[8:9], v13 offset:8192
    ds_read_b64_tr_b16 a[10:11], v13 offset:12288
    s_lshl_b32 s34, s25, 6
    s_add_u32 s34, s34, 32
    v_xor_b32 v13, s34, v12
    v_add_u32 v13, 0, v13
    ds_read_b64_tr_b16 a[4:5], v13 offset:0
    ds_read_b64_tr_b16 a[6:7], v13 offset:4096
    ds_read_b64_tr_b16 a[12:13], v13 offset:8192
    ds_read_b64_tr_b16 a[14:15], v13 offset:12288
    s_waitcnt lgkmcnt(0)
    s_waitcnt vmcnt(24)
    s_barrier
    s_lshl_b32 s34, s25, 6
    s_add_u32 s34, s34, 0
    v_xor_b32 v13, s34, v12
    v_add_u32 v13, 16384, v13
    ds_read_b64_tr_b16 a[16:17], v13 offset:0
    ds_read_b64_tr_b16 a[18:19], v13 offset:4096
    ds_read_b64_tr_b16 a[24:25], v13 offset:8192
    ds_read_b64_tr_b16 a[26:27], v13 offset:12288
    s_lshl_b32 s34, s25, 6
    s_add_u32 s34, s34, 32
    v_xor_b32 v13, s34, v12
    v_add_u32 v13, 16384, v13
    ds_read_b64_tr_b16 a[20:21], v13 offset:0
    ds_read_b64_tr_b16 a[22:23], v13 offset:4096
    ds_read_b64_tr_b16 a[28:29], v13 offset:8192
    ds_read_b64_tr_b16 a[30:31], v13 offset:12288
    s_waitcnt lgkmcnt(0)
    s_waitcnt vmcnt(20)
    s_barrier
    s_lshl_b32 s34, s25, 6
    s_add_u32 s34, s34, 0
    v_xor_b32 v13, s34, v12
    v_add_u32 v13, 32768, v13
    ds_read_b64_tr_b16 a[32:33], v13 offset:0
    ds_read_b64_tr_b16 a[34:35], v13 offset:4096
    ds_read_b64_tr_b16 a[40:41], v13 offset:8192
    ds_read_b64_tr_b16 a[42:43], v13 offset:12288
    s_lshl_b32 s34, s25, 6
    s_add_u32 s34, s34, 32
    v_xor_b32 v13, s34, v12
    v_add_u32 v13, 32768, v13
    ds_read_b64_tr_b16 a[36:37], v13 offset:0
    ds_read_b64_tr_b16 a[38:39], v13 offset:4096
    ds_read_b64_tr_b16 a[44:45], v13 offset:8192
    ds_read_b64_tr_b16 a[46:47], v13 offset:12288
    s_waitcnt lgkmcnt(0)
    s_waitcnt vmcnt(16)
    s_barrier
    s_lshl_b32 s34, s25, 6
    s_add_u32 s34, s34, 0
    v_xor_b32 v13, s34, v12
    v_add_u32 v13, 49152, v13
    ds_read_b64_tr_b16 a[48:49], v13 offset:0
    ds_read_b64_tr_b16 a[50:51], v13 offset:4096
    ds_read_b64_tr_b16 a[56:57], v13 offset:8192
    ds_read_b64_tr_b16 a[58:59], v13 offset:12288
    s_lshl_b32 s34, s25, 6
    s_add_u32 s34, s34, 32
    v_xor_b32 v13, s34, v12
    v_add_u32 v13, 49152, v13
    ds_read_b64_tr_b16 a[52:53], v13 offset:0
    ds_read_b64_tr_b16 a[54:55], v13 offset:4096
    ds_read_b64_tr_b16 a[60:61], v13 offset:8192
    ds_read_b64_tr_b16 a[62:63], v13 offset:12288
    s_waitcnt lgkmcnt(0)
    s_waitcnt vmcnt(12)
    s_barrier
    s_lshl_b32 s34, s25, 6
    s_add_u32 s34, s34, 0
    v_xor_b32 v13, s34, v12
    v_add_u32 v13, 65536, v13
    ds_read_b64_tr_b16 a[64:65], v13 offset:0
    ds_read_b64_tr_b16 a[66:67], v13 offset:4096
    ds_read_b64_tr_b16 a[72:73], v13 offset:8192
    ds_read_b64_tr_b16 a[74:75], v13 offset:12288
    s_lshl_b32 s34, s25, 6
    s_add_u32 s34, s34, 32
    v_xor_b32 v13, s34, v12
    v_add_u32 v13, 65536, v13
    ds_read_b64_tr_b16 a[68:69], v13 offset:0
    ds_read_b64_tr_b16 a[70:71], v13 offset:4096
    ds_read_b64_tr_b16 a[76:77], v13 offset:8192
    ds_read_b64_tr_b16 a[78:79], v13 offset:12288
    s_waitcnt lgkmcnt(0)
    s_waitcnt vmcnt(8)
    s_barrier
    s_lshl_b32 s34, s25, 6
    s_add_u32 s34, s34, 0
    v_xor_b32 v13, s34, v12
    v_add_u32 v13, 81920, v13
    ds_read_b64_tr_b16 a[80:81], v13 offset:0
    ds_read_b64_tr_b16 a[82:83], v13 offset:4096
    ds_read_b64_tr_b16 a[88:89], v13 offset:8192
    ds_read_b64_tr_b16 a[90:91], v13 offset:12288
    s_lshl_b32 s34, s25, 6
    s_add_u32 s34, s34, 32
    v_xor_b32 v13, s34, v12
    v_add_u32 v13, 81920, v13
    ds_read_b64_tr_b16 a[84:85], v13 offset:0
    ds_read_b64_tr_b16 a[86:87], v13 offset:4096
    ds_read_b64_tr_b16 a[92:93], v13 offset:8192
    ds_read_b64_tr_b16 a[94:95], v13 offset:12288
    s_waitcnt lgkmcnt(0)
    s_waitcnt vmcnt(4)
    s_barrier
    s_lshl_b32 s34, s25, 6
    s_add_u32 s34, s34, 0
    v_xor_b32 v13, s34, v12
    v_add_u32 v13, 98304, v13
    ds_read_b64_tr_b16 a[96:97], v13 offset:0
    ds_read_b64_tr_b16 a[98:99], v13 offset:4096
    ds_read_b64_tr_b16 a[104:105], v13 offset:8192
    ds_read_b64_tr_b16 a[106:107], v13 offset:12288
    s_lshl_b32 s34, s25, 6
    s_add_u32 s34, s34, 32
    v_xor_b32 v13, s34, v12
    v_add_u32 v13, 98304, v13
    ds_read_b64_tr_b16 a[100:101], v13 offset:0
    ds_read_b64_tr_b16 a[102:103], v13 offset:4096
    ds_read_b64_tr_b16 a[108:109], v13 offset:8192
    ds_read_b64_tr_b16 a[110:111], v13 offset:12288
    s_waitcnt lgkmcnt(0)
    s_waitcnt vmcnt(0)
    s_barrier
    s_lshl_b32 s34, s25, 6
    s_add_u32 s34, s34, 0
    v_xor_b32 v13, s34, v12
    v_add_u32 v13, 114688, v13
    ds_read_b64_tr_b16 a[112:113], v13 offset:0
    ds_read_b64_tr_b16 a[114:115], v13 offset:4096
    ds_read_b64_tr_b16 a[120:121], v13 offset:8192
    ds_read_b64_tr_b16 a[122:123], v13 offset:12288
    s_lshl_b32 s34, s25, 6
    s_add_u32 s34, s34, 32
    v_xor_b32 v13, s34, v12
    v_add_u32 v13, 114688, v13
    ds_read_b64_tr_b16 a[116:117], v13 offset:0
    ds_read_b64_tr_b16 a[118:119], v13 offset:4096
    ds_read_b64_tr_b16 a[124:125], v13 offset:8192
    ds_read_b64_tr_b16 a[126:127], v13 offset:12288
    s_waitcnt lgkmcnt(0)
    s_add_u32 s16, s44, 41943040
    s_addc_u32 s17, s45, 0
    s_mov_b32 s18, 16777216
    s_mov_b32 s19, 0x20000
    s_add_u32 s20, s44, 67108864
    s_addc_u32 s21, s45, 0
    s_mov_b32 s22, 16777216
    s_mov_b32 s23, 0x20000
    v_lshl_add_u32 v8, v5, 2, 0
    v_cmp_le_u32 s[50:51], v8, v4
    v_lshl_add_u32 v8, v5, 2, 1
    v_cmp_le_u32 s[52:53], v8, v4
    v_lshl_add_u32 v8, v5, 2, 2
    v_cmp_le_u32 s[54:55], v8, v4
    v_lshl_add_u32 v8, v5, 2, 3
    v_cmp_le_u32 s[56:57], v8, v4
    s_mov_b32 s58, 0x3e0293ee
    v_mov_b32 v176, 0x3f803f80
    v_mov_b32 v177, 0x3f803f80
    v_mov_b32 v178, 0x3f803f80
    v_mov_b32 v179, 0x3f803f80
    v_mov_b32 v172, 0
    v_mov_b32 v188, 0
    v_mov_b32 v173, 0
    v_mov_b32 v189, 0
    v_mov_b32 v174, 0
    v_mov_b32 v190, 0
    v_mov_b32 v175, 0
    v_mov_b32 v191, 0
    v_mov_b32 v182, 0
    v_mov_b32 v183, 0
    v_lshlrev_b32 v9, 2, v3
    s_lshl_b32 s61, s28, 7
    s_add_u32 s61, s61, 1024
    s_mov_b32 s34, 256
    s_mov_b32 s35, 224
    v_mov_b32 v10, 0
AT_wkv:
    buffer_load_dword v11, v10, s[40:43], s34 offen sc1
    s_waitcnt vmcnt(0)
    v_readfirstlane_b32 s36, v11
    s_nop 1
    s_cmp_ge_u32 s36, s35
    s_nop 1
    s_cbranch_scc1 AT_wkv_ok
    s_cmp_eq_u32 s33, 0
    s_cbranch_scc1 AT_wkv_ok
    s_sub_u32 s33, s33, 1
    s_sleep 2
    s_branch AT_wkv
AT_wkv_ok:
    s_mov_b32 s26, s29
    s_mov_b32 s27, 0
    s_barrier
    s_lshl_b32 s34, s26, 15
    s_lshl_b32 s35, s25, 13
    s_add_u32 s34, s34, s35
    s_add_u32 s35, s35, s27
    s_mov_b32 m0, s35
    s_nop 0
    buffer_load_dwordx4 v1, s[8:11], s34 offen offset:0 sc1 lds
    buffer_load_dwordx4 v1, s[8:11], s34 offen offset:1024 sc1 lds
    buffer_load_dwordx4 v1, s[8:11], s34 offen offset:2048 sc1 lds
    buffer_load_dwordx4 v1, s[8:11], s34 offen offset:3072 sc1 lds
    s_add_u32 m0, s35, 4096
    s_add_u32 s34, s34, 4096
    buffer_load_dwordx4 v1, s[8:11], s34 offen offset:0 sc1 lds
    buffer_load_dwordx4 v1, s[8:11], s34 offen offset:1024 sc1 lds
    buffer_load_dwordx4 v1, s[8:11], s34 offen offset:2048 sc1 lds
    buffer_load_dwordx4 v1, s[8:11], s34 offen offset:3072 sc1 lds
    s_waitcnt vmcnt(0)
    s_barrier
AT_loop:
    s_add_u32 s48, s26, 2
    s_xor_b32 s32, s27, 32768
    s_cmp_ge_u32 s48, 64
    s_cbranch_scc1 AT_nopf
    s_lshl_b32 s34, s48, 15
    s_lshl_b32 s35, s25, 13
    s_add_u32 s34, s34, s35
    s_add_u32 s35, s35, s32
    s_mov_b32 m0, s35
    s_nop 0
    buffer_load_dwordx4 v1, s[8:11], s34 offen offset:0 sc1 lds
    buffer_load_dwordx4 v1, s[8:11], s34 offen offset:1024 sc1 lds
    buffer_load_dwordx4 v1, s[8:11], s34 offen offset:2048 sc1 lds
    buffer_load_dwordx4 v1, s[8:11], s34 offen offset:3072 sc1 lds
    s_add_u32 m0, s35, 4096
    s_add_u32 s34, s34, 4096
    buffer_load_dwordx4 v1, s[8:11], s34 offen offset:0 sc1 lds
    buffer_load_dwordx4 v1, s[8:11], s34 offen offset:1024 sc1 lds
    buffer_load_dwordx4 v1, s[8:11], s34 offen offset:2048 sc1 lds
    buffer_load_dwordx4 v1, s[8:11], s34 offen offset:3072 sc1 lds
AT_nopf:
    v_add_u32 v8, s27, v1
    s_lshl_b32 s59, s26, 5
    s_add_u32 s59, s59, s28
    s_lshl_b32 s59, s59, 2
    s_add_u32 s59, s59, s25
    s_lshl_b32 s60, s59, 11
    s_lshl_b32 s59, s59, 12
    s_lshl_b32 s34, s25, 11
    s_add_u32 m0, s34, 139264
    s_nop 0
    buffer_load_dwordx4 v1, s[12:15], s59 offen offset:0 sc1 lds
    buffer_load_dwordx4 v1, s[12:15], s59 offen offset:1024 sc1 lds
    buffer_load_dwordx4 v[164:167], v1, s[12:15], s59 offen offset:2048 sc1
    buffer_load_dwordx4 v[168:171], v1, s[12:15], s59 offen offset:3072 sc1
    ds_read_b128 v[16:19], v8 offset:0
    ds_read_b128 v[20:23], v8 offset:16384
    ds_read_b128 v[24:27], v8 offset:1024
    ds_read_b128 v[28:31], v8 offset:17408
    s_waitcnt lgkmcnt(3)
    v_mfma_f32_16x16x32_bf16 v[40:43], a[0:3], v[16:19], 0
    ds_read_b128 v[32:35], v8 offset:2048
    v_mfma_f32_16x16x32_bf16 v[44:47], a[4:7], v[16:19], 0
    ds_read_b128 v[36:39], v8 offset:18432
    s_waitcnt lgkmcnt(4)
    v_mfma_f32_16x16x32_bf16 v[48:51], a[0:3], v[20:23], 0
    v_mfma_f32_16x16x32_bf16 v[52:55], a[4:7], v[20:23], 0
    s_waitcnt lgkmcnt(3)
    v_mfma_f32_16x16x32_bf16 v[40:43], a[8:11], v[24:27], v[40:43]
    ds_read_b128 v[16:19], v8 offset:3072
    v_mfma_f32_16x16x32_bf16 v[44:47], a[12:15], v[24:27], v[44:47]
    ds_read_b128 v[20:23], v8 offset:19456
    s_waitcnt lgkmcnt(4)
    v_mfma_f32_16x16x32_bf16 v[48:51], a[8:11], v[28:31], v[48:51]
    v_mfma_f32_16x16x32_bf16 v[52:55], a[12:15], v[28:31], v[52:55]
    s_waitcnt lgkmcnt(3)
    v_mfma_f32_16x16x32_bf16 v[40:43], a[16:19], v[32:35], v[40:43]
    ds_read_b128 v[24:27], v8 offset:4096
    v_mfma_f32_16x16x32_bf16 v[44:47], a[20:23], v[32:35], v[44:47]
    ds_read_b128 v[28:31], v8 offset:20480
    s_waitcnt lgkmcnt(4)
    v_mfma_f32_16x16x32_bf16 v[48:51], a[16:19], v[36:39], v[48:51]
    v_mfma_f32_16x16x32_bf16 v[52:55], a[20:23], v[36:39], v[52:55]
    s_waitcnt lgkmcnt(3)
    v_mfma_f32_16x16x32_bf16 v[40:43], a[24:27], v[16:19], v[40:43]
    ds_read_b128 v[32:35], v8 offset:5120
    v_mfma_f32_16x16x32_bf16 v[44:47], a[28:31], v[16:19], v[44:47]
    ds_read_b128 v[36:39], v8 offset:21504
    s_waitcnt lgkmcnt(4)
    v_mfma_f32_16x16x32_bf16 v[48:51], a[24:27], v[20:23], v[48:51]
    v_mfma_f32_16x16x32_bf16 v[52:55], a[28:31], v[20:23], v[52:55]
    s_waitcnt lgkmcnt(3)
    v_mfma_f32_16x16x32_bf16 v[40:43], a[32:35], v[24:27], v[40:43]
    ds_read_b128 v[16:19], v8 offset:6144
    v_mfma_f32_16x16x32_bf16 v[44:47], a[36:39], v[24:27], v[44:47]
    ds_read_b128 v[20:23], v8 offset:22528
    s_waitcnt lgkmcnt(4)
    v_mfma_f32_16x16x32_bf16 v[48:51], a[32:35], v[28:31], v[48:51]
    v_mfma_f32_16x16x32_bf16 v[52:55], a[36:39], v[28:31], v[52:55]
    s_waitcnt lgkmcnt(3)
    v_mfma_f32_16x16x32_bf16 v[40:43], a[40:43], v[32:35], v[40:43]
    ds_read_b128 v[24:27], v8 offset:7168
    v_mfma_f32_16x16x32_bf16 v[44:47], a[44:47], v[32:35], v[44:47]
    ds_read_b128 v[28:31], v8 offset:23552
    s_waitcnt lgkmcnt(4)
    v_mfma_f32_16x16x32_bf16 v[48:51], a[40:43], v[36:39], v[48:51]
    v_mfma_f32_16x16x32_bf16 v[52:55], a[44:47], v[36:39], v[52:55]
    s_waitcnt lgkmcnt(3)
    v_mfma_f32_16x16x32_bf16 v[40:43], a[48:51], v[16:19], v[40:43]
    ds_read_b128 v[32:35], v8 offset:8192
    v_mfma_f32_16x16x32_bf16 v[44:47], a[52:55], v[16:19], v[44:47]
    ds_read_b128 v[36:39], v8 offset:24576
    s_waitcnt lgkmcnt(4)
    v_mfma_f32_16x16x32_bf16 v[48:51], a[48:51], v[20:23], v[48:51]
    v_mfma_f32_16x16x32_bf16 v[52:55], a[52:55], v[20:23], v[52:55]
    s_waitcnt lgkmcnt(3)
    v_mfma_f32_16x16x32_bf16 v[40:43], a[56:59], v[24:27], v[40:43]
    ds_read_b128 v[16:19], v8 offset:9216
    v_mfma_f32_16x16x32_bf16 v[44:47], a[60:63], v[24:27], v[44:47]
    ds_read_b128 v[20:23], v8 offset:25600
    s_waitcnt lgkmcnt(4)
    v_mfma_f32_16x16x32_bf16 v[48:51], a[56:59], v[28:31], v[48:51]
    v_mfma_f32_16x16x32_bf16 v[52:55], a[60:63], v[28:31], v[52:55]
    s_waitcnt lgkmcnt(3)
    v_mfma_f32_16x16x32_bf16 v[40:43], a[64:67], v[32:35], v[40:43]
    ds_read_b128 v[24:27], v8 offset:10240
    v_mfma_f32_16x16x32_bf16 v[44:47], a[68:71], v[32:35], v[44:47]
    ds_read_b128 v[28:31], v8 offset:26624
    s_waitcnt lgkmcnt(4)
    v_mfma_f32_16x16x32_bf16 v[48:51], a[64:67], v[36:39], v[48:51]
    v_mfma_f32_16x16x32_bf16 v[52:55], a[68:71], v[36:39], v[52:55]
    s_waitcnt lgkmcnt(3)
    v_mfma_f32_16x16x32_bf16 v[40:43], a[72:75], v[16:19], v[40:43]
    ds_read_b128 v[32:35], v8 offset:11264
    v_mfma_f32_16x16x32_bf16 v[44:47], a[76:79], v[16:19], v[44:47]
    ds_read_b128 v[36:39], v8 offset:27648
    s_waitcnt lgkmcnt(4)
    v_mfma_f32_16x16x32_bf16 v[48:51], a[72:75], v[20:23], v[48:51]
    v_mfma_f32_16x16x32_bf16 v[52:55], a[76:79], v[20:23], v[52:55]
    s_waitcnt lgkmcnt(3)
    v_mfma_f32_16x16x32_bf16 v[40:43], a[80:83], v[24:27], v[40:43]
    ds_read_b128 v[16:19], v8 offset:12288
    v_mfma_f32_16x16x32_bf16 v[44:47], a[84:87], v[24:27], v[44:47]
    ds_read_b128 v[20:23], v8 offset:28672
    s_waitcnt lgkmcnt(4)
    v_mfma_f32_16x16x32_bf16 v[48:51], a[80:83], v[28:31], v[48:51]
    v_mfma_f32_16x16x32_bf16 v[52:55], a[84:87], v[28:31], v[52:55]
    s_waitcnt lgkmcnt(3)
    v_mfma_f32_16x16x32_bf16 v[40:43], a[88:91], v[32:35], v[40:43]
    ds_read_b128 v[24:27], v8 offset:13312
    v_mfma_f32_16x16x32_bf16 v[44:47], a[92:95], v[32:35], v[44:47]
    ds_read_b128 v[28:31], v8 offset:29696
    s_waitcnt lgkmcnt(4)
    v_mfma_f32_16x16x32_bf16 v[48:51], a[88:91], v[36:39], v[48:51]
    v_mfma_f32_16x16x32_bf16 v[52:55], a[92:95], v[36:39], v[52:55]
    s_waitcnt lgkmcnt(3)
    v_mfma_f32_16x16x32_bf16 v[40:43], a[96:99], v[16:19], v[40:43]
    ds_read_b128 v[32:35], v8 offset:14336
    v_mfma_f32_16x16x32_bf16 v[44:47], a[100:103], v[16:19], v[44:47]
    ds_read_b128 v[36:39], v8 offset:30720
    s_waitcnt lgkmcnt(4)
    v_mfma_f32_16x16x32_bf16 v[48:51], a[96:99], v[20:23], v[48:51]
    v_mfma_f32_16x16x32_bf16 v[52:55], a[100:103], v[20:23], v[52:55]
    s_waitcnt lgkmcnt(3)
    v_mfma_f32_16x16x32_bf16 v[40:43], a[104:107], v[24:27], v[40:43]
    ds_read_b128 v[16:19], v8 offset:15360
    v_mfma_f32_16x16x32_bf16 v[44:47], a[108:111], v[24:27], v[44:47]
    ds_read_b128 v[20:23], v8 offset:31744
    s_waitcnt lgkmcnt(4)
    v_mfma_f32_16x16x32_bf16 v[48:51], a[104:107], v[28:31], v[48:51]
    v_mfma_f32_16x16x32_bf16 v[52:55], a[108:111], v[28:31], v[52:55]
    s_waitcnt lgkmcnt(3)
    v_mfma_f32_16x16x32_bf16 v[40:43], a[112:115], v[32:35], v[40:43]
    v_mfma_f32_16x16x32_bf16 v[44:47], a[116:119], v[32:35], v[44:47]
    s_waitcnt lgkmcnt(2)
    v_mfma_f32_16x16x32_bf16 v[48:51], a[112:115], v[36:39], v[48:51]
    v_mfma_f32_16x16x32_bf16 v[52:55], a[116:119], v[36:39], v[52:55]
    s_waitcnt lgkmcnt(1)
    v_mfma_f32_16x16x32_bf16 v[40:43], a[120:123], v[16:19], v[40:43]
    v_mfma_f32_16x16x32_bf16 v[44:47], a[124:127], v[16:19], v[44:47]
    s_waitcnt lgkmcnt(0)
    v_mfma_f32_16x16x32_bf16 v[48:51], a[120:123], v[20:23], v[48:51]
    v_mfma_f32_16x16x32_bf16 v[52:55], a[124:127], v[20:23], v[52:55]
    v_cvt_pk_bf16_f32 v56, v40, v41
    v_cvt_pk_bf16_f32 v57, v42, v43
    v_cvt_pk_bf16_f32 v58, v44, v45
    v_cvt_pk_bf16_f32 v59, v46, v47
    v_cvt_pk_bf16_f32 v60, v48, v49
    v_cvt_pk_bf16_f32 v61, v50, v51
    s_nop 1
    v_cvt_pk_bf16_f32 v62, v52, v53
    v_cvt_pk_bf16_f32 v63, v54, v55
    s_lshl_b32 s34, s25, 10
    s_add_u32 s34, s34, 131072
    v_add_u32 v10, s34, v1
    ds_write_b128 v10, v[56:59] offset:0
    ds_write_b128 v10, v[60:63] offset:4096
    s_waitcnt vmcnt(0) lgkmcnt(0)
    s_barrier
    v_add_u32 v10, 131072, v1
    ds_read_b128 v[64:67], v10 offset:0
    ds_read_b128 v[68:71], v10 offset:1024
    ds_read_b128 v[72:75], v10 offset:2048
    ds_read_b128 v[76:79], v10 offset:3072
    ds_read_b128 v[80:83], v10 offset:4096
    ds_read_b128 v[84:87], v10 offset:5120
    ds_read_b128 v[88:91], v10 offset:6144
    ds_read_b128 v[92:95], v10 offset:7168
    ds_read_b128 v[96:99], v10 offset:8192
    ds_read_b128 v[100:103], v10 offset:9216
    ds_read_b128 v[104:107], v10 offset:10240
    ds_read_b128 v[108:111], v10 offset:11264
    ds_read_b128 v[112:115], v10 offset:12288
    ds_read_b128 v[116:119], v10 offset:13312
    ds_read_b128 v[120:123], v10 offset:14336
    ds_read_b128 v[124:127], v10 offset:15360
    s_waitcnt lgkmcnt(7)
    v_mfma_f32_16x16x32_bf16 v[128:131], v[96:99], v[64:67], 0
    v_mfma_f32_16x16x32_bf16 v[132:135], v[96:99], v[80:83], 0
    s_waitcnt lgkmcnt(6)
    v_mfma_f32_16x16x32_bf16 v[136:139], v[100:103], v[80:83], 0
    s_waitcnt lgkmcnt(5)
    v_mfma_f32_16x16x32_bf16 v[128:131], v[104:107], v[68:71], v[128:131]
    v_mfma_f32_16x16x32_bf16 v[132:135], v[104:107], v[84:87], v[132:135]
    s_waitcnt lgkmcnt(4)
    v_mfma_f32_16x16x32_bf16 v[136:139], v[108:111], v[84:87], v[136:139]
    s_waitcnt lgkmcnt(3)
    v_mfma_f32_16x16x32_bf16 v[128:131], v[112:115], v[72:75], v[128:131]
    v_mfma_f32_16x16x32_bf16 v[132:135], v[112:115], v[88:91], v[132:135]
    s_waitcnt lgkmcnt(2)
    v_mfma_f32_16x16x32_bf16 v[136:139], v[116:119], v[88:91], v[136:139]
    s_waitcnt lgkmcnt(1)
    v_mfma_f32_16x16x32_bf16 v[128:131], v[120:123], v[76:79], v[128:131]
    v_mfma_f32_16x16x32_bf16 v[132:135], v[120:123], v[92:95], v[132:135]
    s_waitcnt lgkmcnt(0)
    v_mfma_f32_16x16x32_bf16 v[136:139], v[124:127], v[92:95], v[136:139]
    v_mov_b32 v10, 0xff800000
    v_cndmask_b32 v128, v10, v128, s[50:51]
    v_cndmask_b32 v129, v10, v129, s[52:53]
    v_cndmask_b32 v130, v10, v130, s[54:55]
    v_cndmask_b32 v131, v10, v131, s[56:57]
    s_nop 2
    v_cndmask_b32 v136, v10, v136, s[50:51]
    v_cndmask_b32 v137, v10, v137, s[52:53]
    v_cndmask_b32 v138, v10, v138, s[54:55]
    v_cndmask_b32 v139, v10, v139, s[56:57]
    s_add_u32 s34, s26, 1
    s_mov_b32 s35, s34
    s_mov_b32 s34, s61
    v_mov_b32 v10, 0
AT_wm:
    buffer_load_dword v11, v10, s[40:43], s34 offen sc1
    s_waitcnt vmcnt(0)
    v_readfirstlane_b32 s36, v11
    s_nop 1
    s_cmp_ge_u32 s36, s35
    s_nop 1
    s_cbranch_scc1 AT_wm_ok
    s_cmp_eq_u32 s33, 0
    s_cbranch_scc1 AT_wm_ok
    s_sub_u32 s33, s33, 1
    s_sleep 2
    s_branch AT_wm
AT_wm_ok:
    s_lshl_b32 s34, s25, 11
    s_sub_u32 s34, s60, s34
    buffer_load_dwordx4 v[148:151], v1, s[16:19], s34 offen sc1
    s_add_u32 s34, s34, 2048
    buffer_load_dwordx4 v[152:155], v1, s[16:19], s34 offen sc1
    s_add_u32 s34, s34, 2048
    buffer_load_dwordx4 v[156:159], v1, s[16:19], s34 offen sc1
    s_add_u32 s34, s34, 2048
    buffer_load_dwordx4 v[160:163], v1, s[16:19], s34 offen sc1
    buffer_load_dword v172, v9, s[16:19], s60 offen offset:1024 sc1
    buffer_load_dword v174, v9, s[16:19], s60 offen offset:1280 sc1
    s_waitcnt vmcnt(5)
    v_mfma_f32_16x16x32_bf16 v[140:143], v[148:151], v[64:67], 0
    v_mfma_f32_16x16x32_bf16 v[144:147], v[148:151], v[80:83], 0
    s_waitcnt vmcnt(4)
    v_mfma_f32_16x16x32_bf16 v[140:143], v[152:155], v[68:71], v[140:143]
    v_mfma_f32_16x16x32_bf16 v[144:147], v[152:155], v[84:87], v[144:147]
    s_waitcnt vmcnt(3)
    v_mfma_f32_16x16x32_bf16 v[140:143], v[156:159], v[72:75], v[140:143]
    v_mfma_f32_16x16x32_bf16 v[144:147], v[156:159], v[88:91], v[144:147]
    s_waitcnt vmcnt(2)
    v_mfma_f32_16x16x32_bf16 v[140:143], v[160:163], v[76:79], v[140:143]
    v_mfma_f32_16x16x32_bf16 v[144:147], v[160:163], v[92:95], v[144:147]
    s_nop 3
    v_max3_f32 v216, v140, v141, v128
    v_max3_f32 v216, v216, v129, v130
    v_max_f32 v216, v216, v131
    v_mov_b32 v217, v216
    s_nop 1
    v_permlane16_swap_b32 v217, v216
    v_max_f32 v216, v216, v217
    v_mov_b32 v217, v216
    s_nop 1
    v_permlane32_swap_b32 v217, v216
    v_max_f32 v216, v216, v217
    v_mul_f32 v216, s58, v216
    v_fma_f32 v140, v140, s58, -v216
    v_fma_f32 v141, v141, s58, -v216
    v_fma_f32 v128, v128, s58, -v216
    v_fma_f32 v129, v129, s58, -v216
    v_fma_f32 v130, v130, s58, -v216
    v_fma_f32 v131, v131, s58, -v216
    v_exp_f32 v140, v140
    v_exp_f32 v141, v141
    v_exp_f32 v128, v128
    v_exp_f32 v129, v129
    v_exp_f32 v130, v130
    v_exp_f32 v131, v131
    v_cvt_pk_bf16_f32 v188, v140, v141
    v_cvt_pk_bf16_f32 v180, v128, v129
    v_cvt_pk_bf16_f32 v181, v130, v131
    v_max3_f32 v216, v144, v145, v132
    v_max3_f32 v216, v216, v133, v134
    v_max3_f32 v216, v216, v135, v136
    v_max3_f32 v216, v216, v137, v138
    v_max_f32 v216, v216, v139
    v_mov_b32 v217, v216
    s_nop 1
    v_permlane16_swap_b32 v217, v216
    v_max_f32 v216, v216, v217
    v_mov_b32 v217, v216
    s_nop 1
    v_permlane32_swap_b32 v217, v216
    v_max_f32 v216, v216, v217
    v_mul_f32 v216, s58, v216
    v_fma_f32 v144, v144, s58, -v216
    v_fma_f32 v145, v145, s58, -v216
    v_fma_f32 v132, v132, s58, -v216
    v_fma_f32 v133, v133, s58, -v216
    v_fma_f32 v134, v134, s58, -v216
    v_fma_f32 v135, v135, s58, -v216
    v_fma_f32 v136, v136, s58, -v216
    v_fma_f32 v137, v137, s58, -v216
    v_fma_f32 v138, v138, s58, -v216
    v_fma_f32 v139, v139, s58, -v216
    v_exp_f32 v144, v144
    v_exp_f32 v145, v145
    v_exp_f32 v132, v132
    v_exp_f32 v133, v133
    v_exp_f32 v134, v134
    v_exp_f32 v135, v135
    v_exp_f32 v136, v136
    v_exp_f32 v137, v137
    v_exp_f32 v138, v138
    v_exp_f32 v139, v139
    v_cvt_pk_bf16_f32 v190, v144, v145
    v_cvt_pk_bf16_f32 v184, v132, v133
    v_cvt_pk_bf16_f32 v185, v134, v135
    v_cvt_pk_bf16_f32 v186, v136, v137
    v_cvt_pk_bf16_f32 v187, v138, v139
    v_mfma_f32_16x16x16_bf16 v[192:195], v[176:177], v[188:189], 0
    s_waitcnt vmcnt(1)
    v_mfma_f32_16x16x16_bf16 v[200:203], v[172:173], v[188:189], 0
    s_waitcnt vmcnt(0)
    v_mfma_f32_16x16x16_bf16 v[204:207], v[174:175], v[188:189], 0
    v_mfma_f32_16x16x32_bf16 v[192:195], v[176:179], v[180:183], v[192:195]
    v_mfma_f32_16x16x32_bf16 v[200:203], v[164:167], v[180:183], v[200:203]
    v_mfma_f32_16x16x32_bf16 v[204:207], v[168:171], v[180:183], v[204:207]
    v_mfma_f32_16x16x16_bf16 v[196:199], v[176:177], v[190:191], 0
    v_mfma_f32_16x16x16_bf16 v[208:211], v[172:173], v[190:191], 0
    v_mfma_f32_16x16x16_bf16 v[212:215], v[174:175], v[190:191], 0
    v_mfma_f32_16x16x32_bf16 v[196:199], v[176:179], v[184:187], v[196:199]
    v_mfma_f32_16x16x32_bf16 v[208:211], v[164:167], v[184:187], v[208:211]
    v_mfma_f32_16x16x32_bf16 v[212:215], v[168:171], v[184:187], v[212:215]
    s_lshl_b32 s34, s26, 18
    s_lshl_b32 s35, s28, 2
    s_add_u32 s35, s35, s25
    s_lshl_b32 s35, s35, 10
    s_add_u32 s34, s34, s35
    v_rcp_f32 v216, v192
    s_nop 0
    v_mul_f32 v200, v200, v216
    v_mul_f32 v201, v201, v216
    v_mul_f32 v202, v202, v216
    v_mul_f32 v203, v203, v216
    v_mul_f32 v204, v204, v216
    v_mul_f32 v205, v205, v216
    v_mul_f32 v206, v206, v216
    v_mul_f32 v207, v207, v216
    v_cvt_pk_bf16_f32 v56, v200, v201
    v_cvt_pk_bf16_f32 v57, v202, v203
    v_cvt_pk_bf16_f32 v58, v204, v205
    v_cvt_pk_bf16_f32 v59, v206, v207
    buffer_store_dwordx4 v[56:59], v1, s[20:23], s34 offen sc1
    s_add_u32 s34, s34, 131072
    v_rcp_f32 v216, v196
    s_nop 0
    v_mul_f32 v208, v208, v216
    v_mul_f32 v209, v209, v216
    v_mul_f32 v210, v210, v216
    v_mul_f32 v211, v211, v216
    v_mul_f32 v212, v212, v216
    v_mul_f32 v213, v213, v216
    v_mul_f32 v214, v214, v216
    v_mul_f32 v215, v215, v216
    v_cvt_pk_bf16_f32 v60, v208, v209
    v_cvt_pk_bf16_f32 v61, v210, v211
    v_cvt_pk_bf16_f32 v62, v212, v213
    v_cvt_pk_bf16_f32 v63, v214, v215
    buffer_store_dwordx4 v[60:63], v1, s[20:23], s34 offen sc1
    s_lshl_b32 s36, s26, 7
    s_add_u32 s36, s36, 8192
    s_waitcnt vmcnt(0)
    s_barrier
    s_cmp_lg_u32 s25, 0
    s_cbranch_scc1 AT_o_noarr
    v_mov_b32 v8, 1
    s_mov_b64 exec, 1
    buffer_atomic_add v8, v7, s[40:43], s36 offen
    s_mov_b64 exec, -1
AT_o_noarr:
    s_waitcnt vmcnt(0)
    s_barrier
    s_mov_b32 s26, s48
    s_mov_b32 s27, s32
    s_cmp_lt_u32 s26, 64
    s_cbranch_scc1 AT_loop
    s_branch L_end
L_final:
    s_sub_u32 s34, s24, 64
    s_lshr_b32 s28, s34, 4
    s_and_b32 s29, s34, 15
    v_lshrrev_b32 v8, 2, v3
    s_mov_b32 s34, 1024
    v_mul_lo_u32 v8, v8, s34
    v_and_b32 v9, 3, v3
    v_lshl_add_u32 v6, v9, 4, v8
    s_load_dwordx2 s[46:47], s[0:1], 40
    s_waitcnt lgkmcnt(0)
    s_mov_b32 s4, s46
    s_mov_b32 s5, s47
    s_mov_b32 s6, 4194304
    s_mov_b32 s7, 0x20000
    s_load_dwordx2 s[46:47], s[0:1], 80
    s_waitcnt lgkmcnt(0)
    s_mov_b32 s20, s46
    s_mov_b32 s21, s47
    s_mov_b32 s22, 1835008
    s_mov_b32 s23, 0x20000
    s_lshl_b32 s31, s29, 6
    s_lshl_b32 s34, s25, 20
    s_add_u32 s31, s31, s34
    s_lshl_b32 s38, s29, 6
    s_mul_i32 s34, s25, 458752
    s_add_u32 s38, s38, s34
    s_waitcnt vmcnt(0) lgkmcnt(0)
    s_barrier
    s_add_u32 s34, s31, 0
    s_add_u32 m0, s30, 0
    s_nop 0
    buffer_load_dwordx4 v6, s[4:7], s34 offen lds
    s_add_u32 s34, s31, 16384
    s_add_u32 m0, s30, 1024
    s_nop 0
    buffer_load_dwordx4 v6, s[4:7], s34 offen lds
    s_add_u32 s34, s31, 32768
    s_add_u32 m0, s30, 2048
    s_nop 0
    buffer_load_dwordx4 v6, s[4:7], s34 offen lds
    s_add_u32 s34, s31, 49152
    s_add_u32 m0, s30, 3072
    s_nop 0
    buffer_load_dwordx4 v6, s[4:7], s34 offen lds
    s_add_u32 s34, s31, 65536
    s_add_u32 m0, s30, 4096
    s_nop 0
    buffer_load_dwordx4 v6, s[4:7], s34 offen lds
    s_add_u32 s34, s31, 81920
    s_add_u32 m0, s30, 5120
    s_nop 0
    buffer_load_dwordx4 v6, s[4:7], s34 offen lds
    s_add_u32 s34, s31, 98304
    s_add_u32 m0, s30, 6144
    s_nop 0
    buffer_load_dwordx4 v6, s[4:7], s34 offen lds
    s_add_u32 s34, s31, 114688
    s_add_u32 m0, s30, 7168
    s_nop 0
    buffer_load_dwordx4 v6, s[4:7], s34 offen lds
    s_add_u32 s34, s31, 131072
    s_add_u32 m0, s30, 8192
    s_nop 0
    buffer_load_dwordx4 v6, s[4:7], s34 offen lds
    s_add_u32 s34, s31, 147456
    s_add_u32 m0, s30, 9216
    s_nop 0
    buffer_load_dwordx4 v6, s[4:7], s34 offen lds
    s_add_u32 s34, s31, 163840
    s_add_u32 m0, s30, 10240
    s_nop 0
    buffer_load_dwordx4 v6, s[4:7], s34 offen lds
    s_add_u32 s34, s31, 180224
    s_add_u32 m0, s30, 11264
    s_nop 0
    buffer_load_dwordx4 v6, s[4:7], s34 offen lds
    s_add_u32 s34, s31, 196608
    s_add_u32 m0, s30, 12288
    s_nop 0
    buffer_load_dwordx4 v6, s[4:7], s34 offen lds
    s_add_u32 s34, s31, 212992
    s_add_u32 m0, s30, 13312
    s_nop 0
    buffer_load_dwordx4 v6, s[4:7], s34 offen lds
    s_add_u32 s34, s31, 229376
    s_add_u32 m0, s30, 14336
    s_nop 0
    buffer_load_dwordx4 v6, s[4:7], s34 offen lds
    s_add_u32 s34, s31, 245760
    s_add_u32 m0, s30, 15360
    s_nop 0
    buffer_load_dwordx4 v6, s[4:7], s34 offen lds
    s_add_u32 s34, s31, 262144
    s_add_u32 m0, s30, 16384
    s_nop 0
    buffer_load_dwordx4 v6, s[4:7], s34 offen lds
    s_add_u32 s34, s31, 278528
    s_add_u32 m0, s30, 17408
    s_nop 0
    buffer_load_dwordx4 v6, s[4:7], s34 offen lds
    s_add_u32 s34, s31, 294912
    s_add_u32 m0, s30, 18432
    s_nop 0
    buffer_load_dwordx4 v6, s[4:7], s34 offen lds
    s_add_u32 s34, s31, 311296
    s_add_u32 m0, s30, 19456
    s_nop 0
    buffer_load_dwordx4 v6, s[4:7], s34 offen lds
    s_add_u32 s34, s31, 327680
    s_add_u32 m0, s30, 20480
    s_nop 0
    buffer_load_dwordx4 v6, s[4:7], s34 offen lds
    s_add_u32 s34, s31, 344064
    s_add_u32 m0, s30, 21504
    s_nop 0
    buffer_load_dwordx4 v6, s[4:7], s34 offen lds
    s_add_u32 s34, s31, 360448
    s_add_u32 m0, s30, 22528
    s_nop 0
    buffer_load_dwordx4 v6, s[4:7], s34 offen lds
    s_add_u32 s34, s31, 376832
    s_add_u32 m0, s30, 23552
    s_nop 0
    buffer_load_dwordx4 v6, s[4:7], s34 offen lds
    s_add_u32 s34, s31, 393216
    s_add_u32 m0, s30, 24576
    s_nop 0
    buffer_load_dwordx4 v6, s[4:7], s34 offen lds
    s_add_u32 s34, s31, 409600
    s_add_u32 m0, s30, 25600
    s_nop 0
    buffer_load_dwordx4 v6, s[4:7], s34 offen lds
    s_add_u32 s34, s31, 425984
    s_add_u32 m0, s30, 26624
    s_nop 0
    buffer_load_dwordx4 v6, s[4:7], s34 offen lds
    s_add_u32 s34, s31, 442368
    s_add_u32 m0, s30, 27648
    s_nop 0
    buffer_load_dwordx4 v6, s[4:7], s34 offen lds
    s_add_u32 s34, s31, 458752
    s_add_u32 m0, s30, 28672
    s_nop 0
    buffer_load_dwordx4 v6, s[4:7], s34 offen lds
    s_add_u32 s34, s31, 475136
    s_add_u32 m0, s30, 29696
    s_nop 0
    buffer_load_dwordx4 v6, s[4:7], s34 offen lds
    s_add_u32 s34, s31, 491520
    s_add_u32 m0, s30, 30720
    s_nop 0
    buffer_load_dwordx4 v6, s[4:7], s34 offen lds
    s_add_u32 s34, s31, 507904
    s_add_u32 m0, s30, 31744
    s_nop 0
    buffer_load_dwordx4 v6, s[4:7], s34 offen lds
    s_waitcnt vmcnt(28)
    ds_read_b64_tr_b16 a[0:1], v2 offset:0
    ds_read_b64_tr_b16 a[2:3], v2 offset:1024
    ds_read_b64_tr_b16 a[4:5], v2 offset:32
    ds_read_b64_tr_b16 a[6:7], v2 offset:1056
    ds_read_b64_tr_b16 a[8:9], v2 offset:2048
    ds_read_b64_tr_b16 a[10:11], v2 offset:3072
    ds_read_b64_tr_b16 a[12:13], v2 offset:2080
    ds_read_b64_tr_b16 a[14:15], v2 offset:3104
    s_waitcnt lgkmcnt(0)
    s_add_u32 s34, s31, 524288
    s_add_u32 m0, s30, 0
    s_nop 0
    buffer_load_dwordx4 v6, s[4:7], s34 offen lds
    s_add_u32 s34, s31, 540672
    s_add_u32 m0, s30, 1024
    s_nop 0
    buffer_load_dwordx4 v6, s[4:7], s34 offen lds
    s_add_u32 s34, s31, 557056
    s_add_u32 m0, s30, 2048
    s_nop 0
    buffer_load_dwordx4 v6, s[4:7], s34 offen lds
    s_add_u32 s34, s31, 573440
    s_add_u32 m0, s30, 3072
    s_nop 0
    buffer_load_dwordx4 v6, s[4:7], s34 offen lds
    s_waitcnt vmcnt(28)
    ds_read_b64_tr_b16 a[16:17], v2 offset:4096
    ds_read_b64_tr_b16 a[18:19], v2 offset:5120
    ds_read_b64_tr_b16 a[20:21], v2 offset:4128
    ds_read_b64_tr_b16 a[22:23], v2 offset:5152
    ds_read_b64_tr_b16 a[24:25], v2 offset:6144
    ds_read_b64_tr_b16 a[26:27], v2 offset:7168
    ds_read_b64_tr_b16 a[28:29], v2 offset:6176
    ds_read_b64_tr_b16 a[30:31], v2 offset:7200
    s_waitcnt lgkmcnt(0)
    s_add_u32 s34, s31, 589824
    s_add_u32 m0, s30, 4096
    s_nop 0
    buffer_load_dwordx4 v6, s[4:7], s34 offen lds
    s_add_u32 s34, s31, 606208
    s_add_u32 m0, s30, 5120
    s_nop 0
    buffer_load_dwordx4 v6, s[4:7], s34 offen lds
    s_add_u32 s34, s31, 622592
    s_add_u32 m0, s30, 6144
    s_nop 0
    buffer_load_dwordx4 v6, s[4:7], s34 offen lds
    s_add_u32 s34, s31, 638976
    s_add_u32 m0, s30, 7168
    s_nop 0
    buffer_load_dwordx4 v6, s[4:7], s34 offen lds
    s_waitcnt vmcnt(28)
    ds_read_b64_tr_b16 a[32:33], v2 offset:8192
    ds_read_b64_tr_b16 a[34:35], v2 offset:9216
    ds_read_b64_tr_b16 a[36:37], v2 offset:8224
    ds_read_b64_tr_b16 a[38:39], v2 offset:9248
    ds_read_b64_tr_b16 a[40:41], v2 offset:10240
    ds_read_b64_tr_b16 a[42:43], v2 offset:11264
    ds_read_b64_tr_b16 a[44:45], v2 offset:10272
    ds_read_b64_tr_b16 a[46:47], v2 offset:11296
    s_waitcnt lgkmcnt(0)
    s_add_u32 s34, s31, 655360
    s_add_u32 m0, s30, 8192
    s_nop 0
    buffer_load_dwordx4 v6, s[4:7], s34 offen lds
    s_add_u32 s34, s31, 671744
    s_add_u32 m0, s30, 9216
    s_nop 0
    buffer_load_dwordx4 v6, s[4:7], s34 offen lds
    s_add_u32 s34, s31, 688128
    s_add_u32 m0, s30, 10240
    s_nop 0
    buffer_load_dwordx4 v6, s[4:7], s34 offen lds
    s_add_u32 s34, s31, 704512
    s_add_u32 m0, s30, 11264
    s_nop 0
    buffer_load_dwordx4 v6, s[4:7], s34 offen lds
    s_waitcnt vmcnt(28)
    ds_read_b64_tr_b16 a[48:49], v2 offset:12288
    ds_read_b64_tr_b16 a[50:51], v2 offset:13312
    ds_read_b64_tr_b16 a[52:53], v2 offset:12320
    ds_read_b64_tr_b16 a[54:55], v2 offset:13344
    ds_read_b64_tr_b16 a[56:57], v2 offset:14336
    ds_read_b64_tr_b16 a[58:59], v2 offset:15360
    ds_read_b64_tr_b16 a[60:61], v2 offset:14368
    ds_read_b64_tr_b16 a[62:63], v2 offset:15392
    s_waitcnt lgkmcnt(0)
    s_add_u32 s34, s31, 720896
    s_add_u32 m0, s30, 12288
    s_nop 0
    buffer_load_dwordx4 v6, s[4:7], s34 offen lds
    s_add_u32 s34, s31, 737280
    s_add_u32 m0, s30, 13312
    s_nop 0
    buffer_load_dwordx4 v6, s[4:7], s34 offen lds
    s_add_u32 s34, s31, 753664
    s_add_u32 m0, s30, 14336
    s_nop 0
    buffer_load_dwordx4 v6, s[4:7], s34 offen lds
    s_add_u32 s34, s31, 770048
    s_add_u32 m0, s30, 15360
    s_nop 0
    buffer_load_dwordx4 v6, s[4:7], s34 offen lds
    s_waitcnt vmcnt(28)
    ds_read_b64_tr_b16 a[64:65], v2 offset:16384
    ds_read_b64_tr_b16 a[66:67], v2 offset:17408
    ds_read_b64_tr_b16 a[68:69], v2 offset:16416
    ds_read_b64_tr_b16 a[70:71], v2 offset:17440
    ds_read_b64_tr_b16 a[72:73], v2 offset:18432
    ds_read_b64_tr_b16 a[74:75], v2 offset:19456
    ds_read_b64_tr_b16 a[76:77], v2 offset:18464
    ds_read_b64_tr_b16 a[78:79], v2 offset:19488
    s_waitcnt lgkmcnt(0)
    s_add_u32 s34, s31, 786432
    s_add_u32 m0, s30, 16384
    s_nop 0
    buffer_load_dwordx4 v6, s[4:7], s34 offen lds
    s_add_u32 s34, s31, 802816
    s_add_u32 m0, s30, 17408
    s_nop 0
    buffer_load_dwordx4 v6, s[4:7], s34 offen lds
    s_add_u32 s34, s31, 819200
    s_add_u32 m0, s30, 18432
    s_nop 0
    buffer_load_dwordx4 v6, s[4:7], s34 offen lds
    s_add_u32 s34, s31, 835584
    s_add_u32 m0, s30, 19456
    s_nop 0
    buffer_load_dwordx4 v6, s[4:7], s34 offen lds
    s_waitcnt vmcnt(28)
    ds_read_b64_tr_b16 a[80:81], v2 offset:20480
    ds_read_b64_tr_b16 a[82:83], v2 offset:21504
    ds_read_b64_tr_b16 a[84:85], v2 offset:20512
    ds_read_b64_tr_b16 a[86:87], v2 offset:21536
    ds_read_b64_tr_b16 a[88:89], v2 offset:22528
    ds_read_b64_tr_b16 a[90:91], v2 offset:23552
    ds_read_b64_tr_b16 a[92:93], v2 offset:22560
    ds_read_b64_tr_b16 a[94:95], v2 offset:23584
    s_waitcnt lgkmcnt(0)
    s_add_u32 s34, s31, 851968
    s_add_u32 m0, s30, 20480
    s_nop 0
    buffer_load_dwordx4 v6, s[4:7], s34 offen lds
    s_add_u32 s34, s31, 868352
    s_add_u32 m0, s30, 21504
    s_nop 0
    buffer_load_dwordx4 v6, s[4:7], s34 offen lds
    s_add_u32 s34, s31, 884736
    s_add_u32 m0, s30, 22528
    s_nop 0
    buffer_load_dwordx4 v6, s[4:7], s34 offen lds
    s_add_u32 s34, s31, 901120
    s_add_u32 m0, s30, 23552
    s_nop 0
    buffer_load_dwordx4 v6, s[4:7], s34 offen lds
    s_waitcnt vmcnt(28)
    ds_read_b64_tr_b16 a[96:97], v2 offset:24576
    ds_read_b64_tr_b16 a[98:99], v2 offset:25600
    ds_read_b64_tr_b16 a[100:101], v2 offset:24608
    ds_read_b64_tr_b16 a[102:103], v2 offset:25632
    ds_read_b64_tr_b16 a[104:105], v2 offset:26624
    ds_read_b64_tr_b16 a[106:107], v2 offset:27648
    ds_read_b64_tr_b16 a[108:109], v2 offset:26656
    ds_read_b64_tr_b16 a[110:111], v2 offset:27680
    s_waitcnt lgkmcnt(0)
    s_add_u32 s34, s31, 917504
    s_add_u32 m0, s30, 24576
    s_nop 0
    buffer_load_dwordx4 v6, s[4:7], s34 offen lds
    s_add_u32 s34, s31, 933888
    s_add_u32 m0, s30, 25600
    s_nop 0
    buffer_load_dwordx4 v6, s[4:7], s34 offen lds
    s_add_u32 s34, s31, 950272
    s_add_u32 m0, s30, 26624
    s_nop 0
    buffer_load_dwordx4 v6, s[4:7], s34 offen lds
    s_add_u32 s34, s31, 966656
    s_add_u32 m0, s30, 27648
    s_nop 0
    buffer_load_dwordx4 v6, s[4:7], s34 offen lds
    s_waitcnt vmcnt(28)
    ds_read_b64_tr_b16 a[112:113], v2 offset:28672
    ds_read_b64_tr_b16 a[114:115], v2 offset:29696
    ds_read_b64_tr_b16 a[116:117], v2 offset:28704
    ds_read_b64_tr_b16 a[118:119], v2 offset:29728
    ds_read_b64_tr_b16 a[120:121], v2 offset:30720
    ds_read_b64_tr_b16 a[122:123], v2 offset:31744
    ds_read_b64_tr_b16 a[124:125], v2 offset:30752
    ds_read_b64_tr_b16 a[126:127], v2 offset:31776
    s_waitcnt lgkmcnt(0)
    s_add_u32 s34, s31, 983040
    s_add_u32 m0, s30, 28672
    s_nop 0
    buffer_load_dwordx4 v6, s[4:7], s34 offen lds
    s_add_u32 s34, s31, 999424
    s_add_u32 m0, s30, 29696
    s_nop 0
    buffer_load_dwordx4 v6, s[4:7], s34 offen lds
    s_add_u32 s34, s31, 1015808
    s_add_u32 m0, s30, 30720
    s_nop 0
    buffer_load_dwordx4 v6, s[4:7], s34 offen lds
    s_add_u32 s34, s31, 1032192
    s_add_u32 m0, s30, 31744
    s_nop 0
    buffer_load_dwordx4 v6, s[4:7], s34 offen lds
    s_waitcnt vmcnt(28)
    ds_read_b64_tr_b16 a[128:129], v2 offset:0
    ds_read_b64_tr_b16 a[130:131], v2 offset:1024
    ds_read_b64_tr_b16 a[132:133], v2 offset:32
    ds_read_b64_tr_b16 a[134:135], v2 offset:1056
    ds_read_b64_tr_b16 a[136:137], v2 offset:2048
    ds_read_b64_tr_b16 a[138:139], v2 offset:3072
    ds_read_b64_tr_b16 a[140:141], v2 offset:2080
    ds_read_b64_tr_b16 a[142:143], v2 offset:3104
    s_waitcnt lgkmcnt(0)
    s_add_u32 s34, s38, 0
    s_add_u32 m0, s30, 0
    s_nop 0
    buffer_load_dwordx4 v6, s[20:23], s34 offen lds
    s_add_u32 s34, s38, 16384
    s_add_u32 m0, s30, 1024
    s_nop 0
    buffer_load_dwordx4 v6, s[20:23], s34 offen lds
    s_add_u32 s34, s38, 32768
    s_add_u32 m0, s30, 2048
    s_nop 0
    buffer_load_dwordx4 v6, s[20:23], s34 offen lds
    s_add_u32 s34, s38, 49152
    s_add_u32 m0, s30, 3072
    s_nop 0
    buffer_load_dwordx4 v6, s[20:23], s34 offen lds
    s_waitcnt vmcnt(28)
    ds_read_b64_tr_b16 a[144:145], v2 offset:4096
    ds_read_b64_tr_b16 a[146:147], v2 offset:5120
    ds_read_b64_tr_b16 a[148:149], v2 offset:4128
    ds_read_b64_tr_b16 a[150:151], v2 offset:5152
    ds_read_b64_tr_b16 a[152:153], v2 offset:6144
    ds_read_b64_tr_b16 a[154:155], v2 offset:7168
    ds_read_b64_tr_b16 a[156:157], v2 offset:6176
    ds_read_b64_tr_b16 a[158:159], v2 offset:7200
    s_waitcnt lgkmcnt(0)
    s_add_u32 s34, s38, 65536
    s_add_u32 m0, s30, 4096
    s_nop 0
    buffer_load_dwordx4 v6, s[20:23], s34 offen lds
    s_add_u32 s34, s38, 81920
    s_add_u32 m0, s30, 5120
    s_nop 0
    buffer_load_dwordx4 v6, s[20:23], s34 offen lds
    s_add_u32 s34, s38, 98304
    s_add_u32 m0, s30, 6144
    s_nop 0
    buffer_load_dwordx4 v6, s[20:23], s34 offen lds
    s_add_u32 s34, s38, 114688
    s_add_u32 m0, s30, 7168
    s_nop 0
    buffer_load_dwordx4 v6, s[20:23], s34 offen lds
    s_waitcnt vmcnt(28)
    ds_read_b64_tr_b16 a[160:161], v2 offset:8192
    ds_read_b64_tr_b16 a[162:163], v2 offset:9216
    ds_read_b64_tr_b16 a[164:165], v2 offset:8224
    ds_read_b64_tr_b16 a[166:167], v2 offset:9248
    ds_read_b64_tr_b16 a[168:169], v2 offset:10240
    ds_read_b64_tr_b16 a[170:171], v2 offset:11264
    ds_read_b64_tr_b16 a[172:173], v2 offset:10272
    ds_read_b64_tr_b16 a[174:175], v2 offset:11296
    s_waitcnt lgkmcnt(0)
    s_add_u32 s34, s38, 131072
    s_add_u32 m0, s30, 8192
    s_nop 0
    buffer_load_dwordx4 v6, s[20:23], s34 offen lds
    s_add_u32 s34, s38, 147456
    s_add_u32 m0, s30, 9216
    s_nop 0
    buffer_load_dwordx4 v6, s[20:23], s34 offen lds
    s_add_u32 s34, s38, 163840
    s_add_u32 m0, s30, 10240
    s_nop 0
    buffer_load_dwordx4 v6, s[20:23], s34 offen lds
    s_add_u32 s34, s38, 180224
    s_add_u32 m0, s30, 11264
    s_nop 0
    buffer_load_dwordx4 v6, s[20:23], s34 offen lds
    s_waitcnt vmcnt(28)
    ds_read_b64_tr_b16 a[176:177], v2 offset:12288
    ds_read_b64_tr_b16 a[178:179], v2 offset:13312
    ds_read_b64_tr_b16 a[180:181], v2 offset:12320
    ds_read_b64_tr_b16 a[182:183], v2 offset:13344
    ds_read_b64_tr_b16 a[184:185], v2 offset:14336
    ds_read_b64_tr_b16 a[186:187], v2 offset:15360
    ds_read_b64_tr_b16 a[188:189], v2 offset:14368
    ds_read_b64_tr_b16 a[190:191], v2 offset:15392
    s_waitcnt lgkmcnt(0)
    s_add_u32 s34, s38, 196608
    s_add_u32 m0, s30, 12288
    s_nop 0
    buffer_load_dwordx4 v6, s[20:23], s34 offen lds
    s_add_u32 s34, s38, 212992
    s_add_u32 m0, s30, 13312
    s_nop 0
    buffer_load_dwordx4 v6, s[20:23], s34 offen lds
    s_add_u32 s34, s38, 229376
    s_add_u32 m0, s30, 14336
    s_nop 0
    buffer_load_dwordx4 v6, s[20:23], s34 offen lds
    s_add_u32 s34, s38, 245760
    s_add_u32 m0, s30, 15360
    s_nop 0
    buffer_load_dwordx4 v6, s[20:23], s34 offen lds
    s_waitcnt vmcnt(28)
    ds_read_b64_tr_b16 a[192:193], v2 offset:16384
    ds_read_b64_tr_b16 a[194:195], v2 offset:17408
    ds_read_b64_tr_b16 a[196:197], v2 offset:16416
    ds_read_b64_tr_b16 a[198:199], v2 offset:17440
    ds_read_b64_tr_b16 a[200:201], v2 offset:18432
    ds_read_b64_tr_b16 a[202:203], v2 offset:19456
    ds_read_b64_tr_b16 a[204:205], v2 offset:18464
    ds_read_b64_tr_b16 a[206:207], v2 offset:19488
    s_waitcnt lgkmcnt(0)
    s_add_u32 s34, s38, 262144
    s_add_u32 m0, s30, 16384
    s_nop 0
    buffer_load_dwordx4 v6, s[20:23], s34 offen lds
    s_add_u32 s34, s38, 278528
    s_add_u32 m0, s30, 17408
    s_nop 0
    buffer_load_dwordx4 v6, s[20:23], s34 offen lds
    s_add_u32 s34, s38, 294912
    s_add_u32 m0, s30, 18432
    s_nop 0
    buffer_load_dwordx4 v6, s[20:23], s34 offen lds
    s_add_u32 s34, s38, 311296
    s_add_u32 m0, s30, 19456
    s_nop 0
    buffer_load_dwordx4 v6, s[20:23], s34 offen lds
    s_waitcnt vmcnt(28)
    ds_read_b64_tr_b16 a[208:209], v2 offset:20480
    ds_read_b64_tr_b16 a[210:211], v2 offset:21504
    ds_read_b64_tr_b16 a[212:213], v2 offset:20512
    ds_read_b64_tr_b16 a[214:215], v2 offset:21536
    ds_read_b64_tr_b16 a[216:217], v2 offset:22528
    ds_read_b64_tr_b16 a[218:219], v2 offset:23552
    ds_read_b64_tr_b16 a[220:221], v2 offset:22560
    ds_read_b64_tr_b16 a[222:223], v2 offset:23584
    s_waitcnt lgkmcnt(0)
    s_add_u32 s34, s38, 327680
    s_add_u32 m0, s30, 20480
    s_nop 0
    buffer_load_dwordx4 v6, s[20:23], s34 offen lds
    s_add_u32 s34, s38, 344064
    s_add_u32 m0, s30, 21504
    s_nop 0
    buffer_load_dwordx4 v6, s[20:23], s34 offen lds
    s_add_u32 s34, s38, 360448
    s_add_u32 m0, s30, 22528
    s_nop 0
    buffer_load_dwordx4 v6, s[20:23], s34 offen lds
    s_add_u32 s34, s38, 376832
    s_add_u32 m0, s30, 23552
    s_nop 0
    buffer_load_dwordx4 v6, s[20:23], s34 offen lds
    s_waitcnt vmcnt(28)
    ds_read_b64_tr_b16 a[224:225], v2 offset:24576
    ds_read_b64_tr_b16 a[226:227], v2 offset:25600
    ds_read_b64_tr_b16 a[228:229], v2 offset:24608
    ds_read_b64_tr_b16 a[230:231], v2 offset:25632
    ds_read_b64_tr_b16 a[232:233], v2 offset:26624
    ds_read_b64_tr_b16 a[234:235], v2 offset:27648
    ds_read_b64_tr_b16 a[236:237], v2 offset:26656
    ds_read_b64_tr_b16 a[238:239], v2 offset:27680
    s_waitcnt lgkmcnt(0)
    s_add_u32 s34, s38, 393216
    s_add_u32 m0, s30, 24576
    s_nop 0
    buffer_load_dwordx4 v6, s[20:23], s34 offen lds
    s_add_u32 s34, s38, 409600
    s_add_u32 m0, s30, 25600
    s_nop 0
    buffer_load_dwordx4 v6, s[20:23], s34 offen lds
    s_add_u32 s34, s38, 425984
    s_add_u32 m0, s30, 26624
    s_nop 0
    buffer_load_dwordx4 v6, s[20:23], s34 offen lds
    s_add_u32 s34, s38, 442368
    s_add_u32 m0, s30, 27648
    s_nop 0
    buffer_load_dwordx4 v6, s[20:23], s34 offen lds
    s_waitcnt vmcnt(28)
    ds_read_b64_tr_b16 a[240:241], v2 offset:28672
    ds_read_b64_tr_b16 a[242:243], v2 offset:29696
    ds_read_b64_tr_b16 a[244:245], v2 offset:28704
    ds_read_b64_tr_b16 a[246:247], v2 offset:29728
    ds_read_b64_tr_b16 a[248:249], v2 offset:30720
    ds_read_b64_tr_b16 a[250:251], v2 offset:31744
    ds_read_b64_tr_b16 a[252:253], v2 offset:30752
    ds_read_b64_tr_b16 a[254:255], v2 offset:31776
    s_waitcnt lgkmcnt(0)
    s_waitcnt vmcnt(24)
    ds_read_b64_tr_b16 v[144:145], v2 offset:0
    ds_read_b64_tr_b16 v[146:147], v2 offset:1024
    ds_read_b64_tr_b16 v[148:149], v2 offset:32
    ds_read_b64_tr_b16 v[150:151], v2 offset:1056
    ds_read_b64_tr_b16 v[152:153], v2 offset:2048
    ds_read_b64_tr_b16 v[154:155], v2 offset:3072
    ds_read_b64_tr_b16 v[156:157], v2 offset:2080
    ds_read_b64_tr_b16 v[158:159], v2 offset:3104
    s_waitcnt lgkmcnt(0)
    s_waitcnt vmcnt(20)
    ds_read_b64_tr_b16 v[160:161], v2 offset:4096
    ds_read_b64_tr_b16 v[162:163], v2 offset:5120
    ds_read_b64_tr_b16 v[164:165], v2 offset:4128
    ds_read_b64_tr_b16 v[166:167], v2 offset:5152
    ds_read_b64_tr_b16 v[168:169], v2 offset:6144
    ds_read_b64_tr_b16 v[170:171], v2 offset:7168
    ds_read_b64_tr_b16 v[172:173], v2 offset:6176
    ds_read_b64_tr_b16 v[174:175], v2 offset:7200
    s_waitcnt lgkmcnt(0)
    s_waitcnt vmcnt(16)
    ds_read_b64_tr_b16 v[176:177], v2 offset:8192
    ds_read_b64_tr_b16 v[178:179], v2 offset:9216
    ds_read_b64_tr_b16 v[180:181], v2 offset:8224
    ds_read_b64_tr_b16 v[182:183], v2 offset:9248
    ds_read_b64_tr_b16 v[184:185], v2 offset:10240
    ds_read_b64_tr_b16 v[186:187], v2 offset:11264
    ds_read_b64_tr_b16 v[188:189], v2 offset:10272
    ds_read_b64_tr_b16 v[190:191], v2 offset:11296
    s_waitcnt lgkmcnt(0)
    s_waitcnt vmcnt(12)
    ds_read_b64_tr_b16 v[192:193], v2 offset:12288
    ds_read_b64_tr_b16 v[194:195], v2 offset:13312
    ds_read_b64_tr_b16 v[196:197], v2 offset:12320
    ds_read_b64_tr_b16 v[198:199], v2 offset:13344
    ds_read_b64_tr_b16 v[200:201], v2 offset:14336
    ds_read_b64_tr_b16 v[202:203], v2 offset:15360
    ds_read_b64_tr_b16 v[204:205], v2 offset:14368
    ds_read_b64_tr_b16 v[206:207], v2 offset:15392
    s_waitcnt lgkmcnt(0)
    s_waitcnt vmcnt(8)
    ds_read_b64_tr_b16 v[208:209], v2 offset:16384
    ds_read_b64_tr_b16 v[210:211], v2 offset:17408
    ds_read_b64_tr_b16 v[212:213], v2 offset:16416
    ds_read_b64_tr_b16 v[214:215], v2 offset:17440
    ds_read_b64_tr_b16 v[216:217], v2 offset:18432
    ds_read_b64_tr_b16 v[218:219], v2 offset:19456
    ds_read_b64_tr_b16 v[220:221], v2 offset:18464
    ds_read_b64_tr_b16 v[222:223], v2 offset:19488
    s_waitcnt lgkmcnt(0)
    s_waitcnt vmcnt(4)
    ds_read_b64_tr_b16 v[224:225], v2 offset:20480
    ds_read_b64_tr_b16 v[226:227], v2 offset:21504
    ds_read_b64_tr_b16 v[228:229], v2 offset:20512
    ds_read_b64_tr_b16 v[230:231], v2 offset:21536
    ds_read_b64_tr_b16 v[232:233], v2 offset:22528
    ds_read_b64_tr_b16 v[234:235], v2 offset:23552
    ds_read_b64_tr_b16 v[236:237], v2 offset:22560
    ds_read_b64_tr_b16 v[238:239], v2 offset:23584
    s_waitcnt lgkmcnt(0)
    s_waitcnt vmcnt(0)
    ds_read_b64_tr_b16 v[240:241], v2 offset:24576
    ds_read_b64_tr_b16 v[242:243], v2 offset:25600
    ds_read_b64_tr_b16 v[244:245], v2 offset:24608
    ds_read_b64_tr_b16 v[246:247], v2 offset:25632
    ds_read_b64_tr_b16 v[248:249], v2 offset:26624
    ds_read_b64_tr_b16 v[250:251], v2 offset:27648
    ds_read_b64_tr_b16 v[252:253], v2 offset:26656
    ds_read_b64_tr_b16 v[254:255], v2 offset:27680
    s_waitcnt lgkmcnt(0)
    s_load_dwordx2 s[46:47], s[0:1], 0
    s_waitcnt lgkmcnt(0)
    s_mov_b32 s4, s46
    s_mov_b32 s5, s47
    s_mov_b32 s6, 2097152
    s_mov_b32 s7, 0x20000
    s_load_dwordx2 s[46:47], s[0:1], 88
    s_waitcnt lgkmcnt(0)
    s_mov_b32 s16, s46
    s_mov_b32 s17, s47
    s_mov_b32 s18, 2097152
    s_mov_b32 s19, 0x20000
    s_add_u32 s20, s44, 58720256
    s_addc_u32 s21, s45, 0
    s_mov_b32 s22, 7340032
    s_mov_b32 s23, 0x20000
    s_add_u32 s12, s44, 67108864
    s_addc_u32 s13, s45, 0
    s_mov_b32 s14, 16777216
    s_mov_b32 s15, 0x20000
    v_lshlrev_b32 v9, 10, v4
    v_lshl_add_u32 v9, v5, 3, v9
    s_lshl_b32 s34, s29, 6
    s_and_b32 s35, s25, 1
    s_lshl_b32 s35, s35, 5
    s_add_u32 s34, s34, s35
    s_lshr_b32 s35, s25, 1
    s_lshl_b32 s35, s35, 14
    s_add_u32 s34, s34, s35
    v_add_u32 v9, s34, v9
    s_lshl_b32 s34, s25, 12
    s_add_u32 s34, s34, 131072
    v_add_u32 v10, s34, v1
    s_lshl_b32 s34, s25, 10
    s_add_u32 s34, s34, 131072
    v_add_u32 v11, s34, v1
    s_mov_b32 s34, 384
    s_mov_b32 s35, 224
    v_mov_b32 v12, 0
FN_wf1:
    buffer_load_dword v13, v12, s[40:43], s34 offen sc1
    s_waitcnt vmcnt(0)
    v_readfirstlane_b32 s36, v13
    s_nop 1
    s_cmp_ge_u32 s36, s35
    s_nop 1
    s_cbranch_scc1 FN_wf1_ok
    s_cmp_eq_u32 s33, 0
    s_cbranch_scc1 FN_wf1_ok
    s_sub_u32 s33, s33, 1
    s_sleep 2
    s_branch FN_wf1
FN_wf1_ok:
    s_mov_b32 s26, s28
FN_loop:
    s_lshl_b32 s32, s26, 15
    buffer_load_dwordx2 v[12:13], v9, s[4:7], s32 offen
    s_mul_i32 s50, s26, 114688
    s_mul_i32 s34, s25, 14336
    s_add_u32 s50, s50, s34
    s_add_u32 s34, s50, 0
    buffer_load_dwordx4 v[16:19], v1, s[20:23], s34 offen offset:0 sc1
    s_add_u32 s34, s50, 57344
    buffer_load_dwordx4 v[20:23], v1, s[20:23], s34 offen offset:0 sc1
    s_add_u32 s34, s50, 0
    buffer_load_dwordx4 v[24:27], v1, s[20:23], s34 offen offset:1024 sc1
    s_add_u32 s34, s50, 57344
    buffer_load_dwordx4 v[28:31], v1, s[20:23], s34 offen offset:1024 sc1
    s_add_u32 s34, s50, 0
    buffer_load_dwordx4 v[32:35], v1, s[20:23], s34 offen offset:2048 sc1
    s_add_u32 s34, s50, 57344
    buffer_load_dwordx4 v[36:39], v1, s[20:23], s34 offen offset:2048 sc1
    s_add_u32 s34, s50, 0
    buffer_load_dwordx4 v[40:43], v1, s[20:23], s34 offen offset:3072 sc1
    s_add_u32 s34, s50, 57344
    buffer_load_dwordx4 v[44:47], v1, s[20:23], s34 offen offset:3072 sc1
    s_add_u32 s34, s50, 4096
    buffer_load_dwordx4 v[48:51], v1, s[20:23], s34 offen offset:0 sc1
    s_add_u32 s34, s50, 61440
    buffer_load_dwordx4 v[52:55], v1, s[20:23], s34 offen offset:0 sc1
    s_add_u32 s34, s50, 4096
    buffer_load_dwordx4 v[56:59], v1, s[20:23], s34 offen offset:1024 sc1
    s_add_u32 s34, s50, 61440
    buffer_load_dwordx4 v[60:63], v1, s[20:23], s34 offen offset:1024 sc1
    s_add_u32 s34, s50, 4096
    buffer_load_dwordx4 v[64:67], v1, s[20:23], s34 offen offset:2048 sc1
    s_add_u32 s34, s50, 61440
    buffer_load_dwordx4 v[68:71], v1, s[20:23], s34 offen offset:2048 sc1
    s_add_u32 s34, s50, 4096
    buffer_load_dwordx4 v[72:75], v1, s[20:23], s34 offen offset:3072 sc1
    s_add_u32 s34, s50, 61440
    buffer_load_dwordx4 v[76:79], v1, s[20:23], s34 offen offset:3072 sc1
    s_waitcnt vmcnt(15)
    v_mfma_f32_16x16x32_bf16 v[80:83], v[144:147], v[16:19], 0
    v_mfma_f32_16x16x32_bf16 v[84:87], v[148:151], v[16:19], 0
    s_add_u32 s34, s50, 8192
    buffer_load_dwordx4 v[16:19], v1, s[20:23], s34 offen offset:0 sc1
    s_waitcnt vmcnt(15)
    v_mfma_f32_16x16x32_bf16 v[88:91], v[144:147], v[20:23], 0
    v_mfma_f32_16x16x32_bf16 v[92:95], v[148:151], v[20:23], 0
    s_add_u32 s34, s50, 65536
    buffer_load_dwordx4 v[20:23], v1, s[20:23], s34 offen offset:0 sc1
    s_waitcnt vmcnt(15)
    v_mfma_f32_16x16x32_bf16 v[80:83], v[152:155], v[24:27], v[80:83]
    v_mfma_f32_16x16x32_bf16 v[84:87], v[156:159], v[24:27], v[84:87]
    s_add_u32 s34, s50, 8192
    buffer_load_dwordx4 v[24:27], v1, s[20:23], s34 offen offset:1024 sc1
    s_waitcnt vmcnt(15)
    v_mfma_f32_16x16x32_bf16 v[88:91], v[152:155], v[28:31], v[88:91]
    v_mfma_f32_16x16x32_bf16 v[92:95], v[156:159], v[28:31], v[92:95]
    s_add_u32 s34, s50, 65536
    buffer_load_dwordx4 v[28:31], v1, s[20:23], s34 offen offset:1024 sc1
    s_waitcnt vmcnt(15)
    v_mfma_f32_16x16x32_bf16 v[80:83], v[160:163], v[32:35], v[80:83]
    v_mfma_f32_16x16x32_bf16 v[84:87], v[164:167], v[32:35], v[84:87]
    s_add_u32 s34, s50, 8192
    buffer_load_dwordx4 v[32:35], v1, s[20:23], s34 offen offset:2048 sc1
    s_waitcnt vmcnt(15)
    v_mfma_f32_16x16x32_bf16 v[88:91], v[160:163], v[36:39], v[88:91]
    v_mfma_f32_16x16x32_bf16 v[92:95], v[164:167], v[36:39], v[92:95]
    s_add_u32 s34, s50, 65536
    buffer_load_dwordx4 v[36:39], v1, s[20:23], s34 offen offset:2048 sc1
    s_waitcnt vmcnt(15)
    v_mfma_f32_16x16x32_bf16 v[80:83], v[168:171], v[40:43], v[80:83]
    v_mfma_f32_16x16x32_bf16 v[84:87], v[172:175], v[40:43], v[84:87]
    s_add_u32 s34, s50, 8192
    buffer_load_dwordx4 v[40:43], v1, s[20:23], s34 offen offset:3072 sc1
    s_waitcnt vmcnt(15)
    v_mfma_f32_16x16x32_bf16 v[88:91], v[168:171], v[44:47], v[88:91]
    v_mfma_f32_16x16x32_bf16 v[92:95], v[172:175], v[44:47], v[92:95]
    s_add_u32 s34, s50, 65536
    buffer_load_dwordx4 v[44:47], v1, s[20:23], s34 offen offset:3072 sc1
    s_waitcnt vmcnt(15)
    v_mfma_f32_16x16x32_bf16 v[80:83], v[176:179], v[48:51], v[80:83]
    v_mfma_f32_16x16x32_bf16 v[84:87], v[180:183], v[48:51], v[84:87]
    s_add_u32 s34, s50, 12288
    buffer_load_dwordx4 v[48:51], v1, s[20:23], s34 offen offset:0 sc1
    s_waitcnt vmcnt(15)
    v_mfma_f32_16x16x32_bf16 v[88:91], v[176:179], v[52:55], v[88:91]
    v_mfma_f32_16x16x32_bf16 v[92:95], v[180:183], v[52:55], v[92:95]
    s_add_u32 s34, s50, 69632
    buffer_load_dwordx4 v[52:55], v1, s[20:23], s34 offen offset:0 sc1
    s_waitcnt vmcnt(15)
    v_mfma_f32_16x16x32_bf16 v[80:83], v[184:187], v[56:59], v[80:83]
    v_mfma_f32_16x16x32_bf16 v[84:87], v[188:191], v[56:59], v[84:87]
    s_add_u32 s34, s50, 12288
    buffer_load_dwordx4 v[56:59], v1, s[20:23], s34 offen offset:1024 sc1
    s_waitcnt vmcnt(15)
    v_mfma_f32_16x16x32_bf16 v[88:91], v[184:187], v[60:63], v[88:91]
    v_mfma_f32_16x16x32_bf16 v[92:95], v[188:191], v[60:63], v[92:95]
    s_add_u32 s34, s50, 69632
    buffer_load_dwordx4 v[60:63], v1, s[20:23], s34 offen offset:1024 sc1
    s_waitcnt vmcnt(15)
    v_mfma_f32_16x16x32_bf16 v[80:83], v[192:195], v[64:67], v[80:83]
    v_mfma_f32_16x16x32_bf16 v[84:87], v[196:199], v[64:67], v[84:87]
    s_waitcnt vmcnt(14)
    v_mfma_f32_16x16x32_bf16 v[88:91], v[192:195], v[68:71], v[88:91]
    v_mfma_f32_16x16x32_bf16 v[92:95], v[196:199], v[68:71], v[92:95]
    s_waitcnt vmcnt(13)
    v_mfma_f32_16x16x32_bf16 v[80:83], v[200:203], v[72:75], v[80:83]
    v_mfma_f32_16x16x32_bf16 v[84:87], v[204:207], v[72:75], v[84:87]
    s_waitcnt vmcnt(12)
    v_mfma_f32_16x16x32_bf16 v[88:91], v[200:203], v[76:79], v[88:91]
    v_mfma_f32_16x16x32_bf16 v[92:95], v[204:207], v[76:79], v[92:95]
    s_waitcnt vmcnt(11)
    v_mfma_f32_16x16x32_bf16 v[80:83], v[208:211], v[16:19], v[80:83]
    v_mfma_f32_16x16x32_bf16 v[84:87], v[212:215], v[16:19], v[84:87]
    s_waitcnt vmcnt(10)
    v_mfma_f32_16x16x32_bf16 v[88:91], v[208:211], v[20:23], v[88:91]
    v_mfma_f32_16x16x32_bf16 v[92:95], v[212:215], v[20:23], v[92:95]
    s_waitcnt vmcnt(9)
    v_mfma_f32_16x16x32_bf16 v[80:83], v[216:219], v[24:27], v[80:83]
    v_mfma_f32_16x16x32_bf16 v[84:87], v[220:223], v[24:27], v[84:87]
    s_waitcnt vmcnt(8)
    v_mfma_f32_16x16x32_bf16 v[88:91], v[216:219], v[28:31], v[88:91]
    v_mfma_f32_16x16x32_bf16 v[92:95], v[220:223], v[28:31], v[92:95]
    s_waitcnt vmcnt(7)
    v_mfma_f32_16x16x32_bf16 v[80:83], v[224:227], v[32:35], v[80:83]
    v_mfma_f32_16x16x32_bf16 v[84:87], v[228:231], v[32:35], v[84:87]
    s_waitcnt vmcnt(6)
    v_mfma_f32_16x16x32_bf16 v[88:91], v[224:227], v[36:39], v[88:91]
    v_mfma_f32_16x16x32_bf16 v[92:95], v[228:231], v[36:39], v[92:95]
    s_waitcnt vmcnt(5)
    v_mfma_f32_16x16x32_bf16 v[80:83], v[232:235], v[40:43], v[80:83]
    v_mfma_f32_16x16x32_bf16 v[84:87], v[236:239], v[40:43], v[84:87]
    s_waitcnt vmcnt(4)
    v_mfma_f32_16x16x32_bf16 v[88:91], v[232:235], v[44:47], v[88:91]
    v_mfma_f32_16x16x32_bf16 v[92:95], v[236:239], v[44:47], v[92:95]
    s_waitcnt vmcnt(3)
    v_mfma_f32_16x16x32_bf16 v[80:83], v[240:243], v[48:51], v[80:83]
    v_mfma_f32_16x16x32_bf16 v[84:87], v[244:247], v[48:51], v[84:87]
    s_waitcnt vmcnt(2)
    v_mfma_f32_16x16x32_bf16 v[88:91], v[240:243], v[52:55], v[88:91]
    v_mfma_f32_16x16x32_bf16 v[92:95], v[244:247], v[52:55], v[92:95]
    s_waitcnt vmcnt(1)
    v_mfma_f32_16x16x32_bf16 v[80:83], v[248:251], v[56:59], v[80:83]
    v_mfma_f32_16x16x32_bf16 v[84:87], v[252:255], v[56:59], v[84:87]
    s_waitcnt vmcnt(0)
    v_mfma_f32_16x16x32_bf16 v[88:91], v[248:251], v[60:63], v[88:91]
    v_mfma_f32_16x16x32_bf16 v[92:95], v[252:255], v[60:63], v[92:95]
    s_lshl_b32 s34, s26, 7
    s_add_u32 s34, s34, 8192
    s_mov_b32 s35, 32
    s_waitcnt vmcnt(0)
    v_mov_b32 v14, 0
FN_wo:
    buffer_load_dword v15, v14, s[40:43], s34 offen sc1
    s_waitcnt vmcnt(0)
    v_readfirstlane_b32 s36, v15
    s_nop 1
    s_cmp_ge_u32 s36, s35
    s_nop 1
    s_cbranch_scc1 FN_wo_ok
    s_cmp_eq_u32 s33, 0
    s_cbranch_scc1 FN_wo_ok
    s_sub_u32 s33, s33, 1
    s_sleep 2
    s_branch FN_wo
FN_wo_ok:
    s_lshl_b32 s50, s26, 18
    s_lshl_b32 s34, s25, 15
    s_add_u32 s50, s50, s34
    s_add_u32 s34, s50, 0
    buffer_load_dwordx4 v[16:19], v1, s[12:15], s34 offen offset:0 sc1
    s_add_u32 s34, s50, 131072
    buffer_load_dwordx4 v[20:23], v1, s[12:15], s34 offen offset:0 sc1
    s_add_u32 s34, s50, 0
    buffer_load_dwordx4 v[24:27], v1, s[12:15], s34 offen offset:1024 sc1
    s_add_u32 s34, s50, 131072
    buffer_load_dwordx4 v[28:31], v1, s[12:15], s34 offen offset:1024 sc1
    s_add_u32 s34, s50, 0
    buffer_load_dwordx4 v[32:35], v1, s[12:15], s34 offen offset:2048 sc1
    s_add_u32 s34, s50, 131072
    buffer_load_dwordx4 v[36:39], v1, s[12:15], s34 offen offset:2048 sc1
    s_add_u32 s34, s50, 0
    buffer_load_dwordx4 v[40:43], v1, s[12:15], s34 offen offset:3072 sc1
    s_add_u32 s34, s50, 131072
    buffer_load_dwordx4 v[44:47], v1, s[12:15], s34 offen offset:3072 sc1
    s_add_u32 s34, s50, 4096
    buffer_load_dwordx4 v[48:51], v1, s[12:15], s34 offen offset:0 sc1
    s_add_u32 s34, s50, 135168
    buffer_load_dwordx4 v[52:55], v1, s[12:15], s34 offen offset:0 sc1
    s_add_u32 s34, s50, 4096
    buffer_load_dwordx4 v[56:59], v1, s[12:15], s34 offen offset:1024 sc1
    s_add_u32 s34, s50, 135168
    buffer_load_dwordx4 v[60:63], v1, s[12:15], s34 offen offset:1024 sc1
    s_add_u32 s34, s50, 4096
    buffer_load_dwordx4 v[64:67], v1, s[12:15], s34 offen offset:2048 sc1
    s_add_u32 s34, s50, 135168
    buffer_load_dwordx4 v[68:71], v1, s[12:15], s34 offen offset:2048 sc1
    s_add_u32 s34, s50, 4096
    buffer_load_dwordx4 v[72:75], v1, s[12:15], s34 offen offset:3072 sc1
    s_add_u32 s34, s50, 135168
    buffer_load_dwordx4 v[76:79], v1, s[12:15], s34 offen offset:3072 sc1
    s_waitcnt vmcnt(15)
    v_mfma_f32_16x16x32_bf16 v[80:83], a[0:3], v[16:19], v[80:83]
    v_mfma_f32_16x16x32_bf16 v[84:87], a[4:7], v[16:19], v[84:87]
    s_add_u32 s34, s50, 8192
    buffer_load_dwordx4 v[16:19], v1, s[12:15], s34 offen offset:0 sc1
    s_waitcnt vmcnt(15)
    v_mfma_f32_16x16x32_bf16 v[88:91], a[0:3], v[20:23], v[88:91]
    v_mfma_f32_16x16x32_bf16 v[92:95], a[4:7], v[20:23], v[92:95]
    s_add_u32 s34, s50, 139264
    buffer_load_dwordx4 v[20:23], v1, s[12:15], s34 offen offset:0 sc1
    s_waitcnt vmcnt(15)
    v_mfma_f32_16x16x32_bf16 v[80:83], a[8:11], v[24:27], v[80:83]
    v_mfma_f32_16x16x32_bf16 v[84:87], a[12:15], v[24:27], v[84:87]
    s_add_u32 s34, s50, 8192
    buffer_load_dwordx4 v[24:27], v1, s[12:15], s34 offen offset:1024 sc1
    s_waitcnt vmcnt(15)
    v_mfma_f32_16x16x32_bf16 v[88:91], a[8:11], v[28:31], v[88:91]
    v_mfma_f32_16x16x32_bf16 v[92:95], a[12:15], v[28:31], v[92:95]
    s_add_u32 s34, s50, 139264
    buffer_load_dwordx4 v[28:31], v1, s[12:15], s34 offen offset:1024 sc1
    s_waitcnt vmcnt(15)
    v_mfma_f32_16x16x32_bf16 v[80:83], a[16:19], v[32:35], v[80:83]
    v_mfma_f32_16x16x32_bf16 v[84:87], a[20:23], v[32:35], v[84:87]
    s_add_u32 s34, s50, 8192
    buffer_load_dwordx4 v[32:35], v1, s[12:15], s34 offen offset:2048 sc1
    s_waitcnt vmcnt(15)
    v_mfma_f32_16x16x32_bf16 v[88:91], a[16:19], v[36:39], v[88:91]
    v_mfma_f32_16x16x32_bf16 v[92:95], a[20:23], v[36:39], v[92:95]
    s_add_u32 s34, s50, 139264
    buffer_load_dwordx4 v[36:39], v1, s[12:15], s34 offen offset:2048 sc1
    s_waitcnt vmcnt(15)
    v_mfma_f32_16x16x32_bf16 v[80:83], a[24:27], v[40:43], v[80:83]
    v_mfma_f32_16x16x32_bf16 v[84:87], a[28:31], v[40:43], v[84:87]
    s_add_u32 s34, s50, 8192
    buffer_load_dwordx4 v[40:43], v1, s[12:15], s34 offen offset:3072 sc1
    s_waitcnt vmcnt(15)
    v_mfma_f32_16x16x32_bf16 v[88:91], a[24:27], v[44:47], v[88:91]
    v_mfma_f32_16x16x32_bf16 v[92:95], a[28:31], v[44:47], v[92:95]
    s_add_u32 s34, s50, 139264
    buffer_load_dwordx4 v[44:47], v1, s[12:15], s34 offen offset:3072 sc1
    s_waitcnt vmcnt(15)
    v_mfma_f32_16x16x32_bf16 v[80:83], a[32:35], v[48:51], v[80:83]
    v_mfma_f32_16x16x32_bf16 v[84:87], a[36:39], v[48:51], v[84:87]
    s_add_u32 s34, s50, 12288
    buffer_load_dwordx4 v[48:51], v1, s[12:15], s34 offen offset:0 sc1
    s_waitcnt vmcnt(15)
    v_mfma_f32_16x16x32_bf16 v[88:91], a[32:35], v[52:55], v[88:91]
    v_mfma_f32_16x16x32_bf16 v[92:95], a[36:39], v[52:55], v[92:95]
    s_add_u32 s34, s50, 143360
    buffer_load_dwordx4 v[52:55], v1, s[12:15], s34 offen offset:0 sc1
    s_waitcnt vmcnt(15)
    v_mfma_f32_16x16x32_bf16 v[80:83], a[40:43], v[56:59], v[80:83]
    v_mfma_f32_16x16x32_bf16 v[84:87], a[44:47], v[56:59], v[84:87]
    s_add_u32 s34, s50, 12288
    buffer_load_dwordx4 v[56:59], v1, s[12:15], s34 offen offset:1024 sc1
    s_waitcnt vmcnt(15)
    v_mfma_f32_16x16x32_bf16 v[88:91], a[40:43], v[60:63], v[88:91]
    v_mfma_f32_16x16x32_bf16 v[92:95], a[44:47], v[60:63], v[92:95]
    s_add_u32 s34, s50, 143360
    buffer_load_dwordx4 v[60:63], v1, s[12:15], s34 offen offset:1024 sc1
    s_waitcnt vmcnt(15)
    v_mfma_f32_16x16x32_bf16 v[80:83], a[48:51], v[64:67], v[80:83]
    v_mfma_f32_16x16x32_bf16 v[84:87], a[52:55], v[64:67], v[84:87]
    s_add_u32 s34, s50, 12288
    buffer_load_dwordx4 v[64:67], v1, s[12:15], s34 offen offset:2048 sc1
    s_waitcnt vmcnt(15)
    v_mfma_f32_16x16x32_bf16 v[88:91], a[48:51], v[68:71], v[88:91]
    v_mfma_f32_16x16x32_bf16 v[92:95], a[52:55], v[68:71], v[92:95]
    s_add_u32 s34, s50, 143360
    buffer_load_dwordx4 v[68:71], v1, s[12:15], s34 offen offset:2048 sc1
    s_waitcnt vmcnt(15)
    v_mfma_f32_16x16x32_bf16 v[80:83], a[56:59], v[72:75], v[80:83]
    v_mfma_f32_16x16x32_bf16 v[84:87], a[60:63], v[72:75], v[84:87]
    s_add_u32 s34, s50, 12288
    buffer_load_dwordx4 v[72:75], v1, s[12:15], s34 offen offset:3072 sc1
    s_waitcnt vmcnt(15)
    v_mfma_f32_16x16x32_bf16 v[88:91], a[56:59], v[76:79], v[88:91]
    v_mfma_f32_16x16x32_bf16 v[92:95], a[60:63], v[76:79], v[92:95]
    s_add_u32 s34, s50, 143360
    buffer_load_dwordx4 v[76:79], v1, s[12:15], s34 offen offset:3072 sc1
    s_waitcnt vmcnt(15)
    v_mfma_f32_16x16x32_bf16 v[80:83], a[64:67], v[16:19], v[80:83]
    v_mfma_f32_16x16x32_bf16 v[84:87], a[68:71], v[16:19], v[84:87]
    s_add_u32 s34, s50, 16384
    buffer_load_dwordx4 v[16:19], v1, s[12:15], s34 offen offset:0 sc1
    s_waitcnt vmcnt(15)
    v_mfma_f32_16x16x32_bf16 v[88:91], a[64:67], v[20:23], v[88:91]
    v_mfma_f32_16x16x32_bf16 v[92:95], a[68:71], v[20:23], v[92:95]
    s_add_u32 s34, s50, 147456
    buffer_load_dwordx4 v[20:23], v1, s[12:15], s34 offen offset:0 sc1
    s_waitcnt vmcnt(15)
    v_mfma_f32_16x16x32_bf16 v[80:83], a[72:75], v[24:27], v[80:83]
    v_mfma_f32_16x16x32_bf16 v[84:87], a[76:79], v[24:27], v[84:87]
    s_add_u32 s34, s50, 16384
    buffer_load_dwordx4 v[24:27], v1, s[12:15], s34 offen offset:1024 sc1
    s_waitcnt vmcnt(15)
    v_mfma_f32_16x16x32_bf16 v[88:91], a[72:75], v[28:31], v[88:91]
    v_mfma_f32_16x16x32_bf16 v[92:95], a[76:79], v[28:31], v[92:95]
    s_add_u32 s34, s50, 147456
    buffer_load_dwordx4 v[28:31], v1, s[12:15], s34 offen offset:1024 sc1
    s_waitcnt vmcnt(15)
    v_mfma_f32_16x16x32_bf16 v[80:83], a[80:83], v[32:35], v[80:83]
    v_mfma_f32_16x16x32_bf16 v[84:87], a[84:87], v[32:35], v[84:87]
    s_add_u32 s34, s50, 16384
    buffer_load_dwordx4 v[32:35], v1, s[12:15], s34 offen offset:2048 sc1
    s_waitcnt vmcnt(15)
    v_mfma_f32_16x16x32_bf16 v[88:91], a[80:83], v[36:39], v[88:91]
    v_mfma_f32_16x16x32_bf16 v[92:95], a[84:87], v[36:39], v[92:95]
    s_add_u32 s34, s50, 147456
    buffer_load_dwordx4 v[36:39], v1, s[12:15], s34 offen offset:2048 sc1
    s_waitcnt vmcnt(15)
    v_mfma_f32_16x16x32_bf16 v[80:83], a[88:91], v[40:43], v[80:83]
    v_mfma_f32_16x16x32_bf16 v[84:87], a[92:95], v[40:43], v[84:87]
    s_add_u32 s34, s50, 16384
    buffer_load_dwordx4 v[40:43], v1, s[12:15], s34 offen offset:3072 sc1
    s_waitcnt vmcnt(15)
    v_mfma_f32_16x16x32_bf16 v[88:91], a[88:91], v[44:47], v[88:91]
    v_mfma_f32_16x16x32_bf16 v[92:95], a[92:95], v[44:47], v[92:95]
    s_add_u32 s34, s50, 147456
    buffer_load_dwordx4 v[44:47], v1, s[12:15], s34 offen offset:3072 sc1
    s_waitcnt vmcnt(15)
    v_mfma_f32_16x16x32_bf16 v[80:83], a[96:99], v[48:51], v[80:83]
    v_mfma_f32_16x16x32_bf16 v[84:87], a[100:103], v[48:51], v[84:87]
    s_add_u32 s34, s50, 20480
    buffer_load_dwordx4 v[48:51], v1, s[12:15], s34 offen offset:0 sc1
    s_waitcnt vmcnt(15)
    v_mfma_f32_16x16x32_bf16 v[88:91], a[96:99], v[52:55], v[88:91]
    v_mfma_f32_16x16x32_bf16 v[92:95], a[100:103], v[52:55], v[92:95]
    s_add_u32 s34, s50, 151552
    buffer_load_dwordx4 v[52:55], v1, s[12:15], s34 offen offset:0 sc1
    s_waitcnt vmcnt(15)
    v_mfma_f32_16x16x32_bf16 v[80:83], a[104:107], v[56:59], v[80:83]
    v_mfma_f32_16x16x32_bf16 v[84:87], a[108:111], v[56:59], v[84:87]
    s_add_u32 s34, s50, 20480
    buffer_load_dwordx4 v[56:59], v1, s[12:15], s34 offen offset:1024 sc1
    s_waitcnt vmcnt(15)
    v_mfma_f32_16x16x32_bf16 v[88:91], a[104:107], v[60:63], v[88:91]
    v_mfma_f32_16x16x32_bf16 v[92:95], a[108:111], v[60:63], v[92:95]
    s_add_u32 s34, s50, 151552
    buffer_load_dwordx4 v[60:63], v1, s[12:15], s34 offen offset:1024 sc1
    s_waitcnt vmcnt(15)
    v_mfma_f32_16x16x32_bf16 v[80:83], a[112:115], v[64:67], v[80:83]
    v_mfma_f32_16x16x32_bf16 v[84:87], a[116:119], v[64:67], v[84:87]
    s_add_u32 s34, s50, 20480
    buffer_load_dwordx4 v[64:67], v1, s[12:15], s34 offen offset:2048 sc1
    s_waitcnt vmcnt(15)
    v_mfma_f32_16x16x32_bf16 v[88:91], a[112:115], v[68:71], v[88:91]
    v_mfma_f32_16x16x32_bf16 v[92:95], a[116:119], v[68:71], v[92:95]
    s_add_u32 s34, s50, 151552
    buffer_load_dwordx4 v[68:71], v1, s[12:15], s34 offen offset:2048 sc1
    s_waitcnt vmcnt(15)
    v_mfma_f32_16x16x32_bf16 v[80:83], a[120:123], v[72:75], v[80:83]
    v_mfma_f32_16x16x32_bf16 v[84:87], a[124:127], v[72:75], v[84:87]
    s_add_u32 s34, s50, 20480
    buffer_load_dwordx4 v[72:75], v1, s[12:15], s34 offen offset:3072 sc1
    s_waitcnt vmcnt(15)
    v_mfma_f32_16x16x32_bf16 v[88:91], a[120:123], v[76:79], v[88:91]
    v_mfma_f32_16x16x32_bf16 v[92:95], a[124:127], v[76:79], v[92:95]
    s_add_u32 s34, s50, 151552
    buffer_load_dwordx4 v[76:79], v1, s[12:15], s34 offen offset:3072 sc1
    s_waitcnt vmcnt(15)
    v_mfma_f32_16x16x32_bf16 v[80:83], a[128:131], v[16:19], v[80:83]
    v_mfma_f32_16x16x32_bf16 v[84:87], a[132:135], v[16:19], v[84:87]
    s_add_u32 s34, s50, 24576
    buffer_load_dwordx4 v[16:19], v1, s[12:15], s34 offen offset:0 sc1
    s_waitcnt vmcnt(15)
    v_mfma_f32_16x16x32_bf16 v[88:91], a[128:131], v[20:23], v[88:91]
    v_mfma_f32_16x16x32_bf16 v[92:95], a[132:135], v[20:23], v[92:95]
    s_add_u32 s34, s50, 155648
    buffer_load_dwordx4 v[20:23], v1, s[12:15], s34 offen offset:0 sc1
    s_waitcnt vmcnt(15)
    v_mfma_f32_16x16x32_bf16 v[80:83], a[136:139], v[24:27], v[80:83]
    v_mfma_f32_16x16x32_bf16 v[84:87], a[140:143], v[24:27], v[84:87]
    s_add_u32 s34, s50, 24576
    buffer_load_dwordx4 v[24:27], v1, s[12:15], s34 offen offset:1024 sc1
    s_waitcnt vmcnt(15)
    v_mfma_f32_16x16x32_bf16 v[88:91], a[136:139], v[28:31], v[88:91]
    v_mfma_f32_16x16x32_bf16 v[92:95], a[140:143], v[28:31], v[92:95]
    s_add_u32 s34, s50, 155648
    buffer_load_dwordx4 v[28:31], v1, s[12:15], s34 offen offset:1024 sc1
    s_waitcnt vmcnt(15)
    v_mfma_f32_16x16x32_bf16 v[80:83], a[144:147], v[32:35], v[80:83]
    v_mfma_f32_16x16x32_bf16 v[84:87], a[148:151], v[32:35], v[84:87]
    s_add_u32 s34, s50, 24576
    buffer_load_dwordx4 v[32:35], v1, s[12:15], s34 offen offset:2048 sc1
    s_waitcnt vmcnt(15)
    v_mfma_f32_16x16x32_bf16 v[88:91], a[144:147], v[36:39], v[88:91]
    v_mfma_f32_16x16x32_bf16 v[92:95], a[148:151], v[36:39], v[92:95]
    s_add_u32 s34, s50, 155648
    buffer_load_dwordx4 v[36:39], v1, s[12:15], s34 offen offset:2048 sc1
    s_waitcnt vmcnt(15)
    v_mfma_f32_16x16x32_bf16 v[80:83], a[152:155], v[40:43], v[80:83]
    v_mfma_f32_16x16x32_bf16 v[84:87], a[156:159], v[40:43], v[84:87]
    s_add_u32 s34, s50, 24576
    buffer_load_dwordx4 v[40:43], v1, s[12:15], s34 offen offset:3072 sc1
    s_waitcnt vmcnt(15)
    v_mfma_f32_16x16x32_bf16 v[88:91], a[152:155], v[44:47], v[88:91]
    v_mfma_f32_16x16x32_bf16 v[92:95], a[156:159], v[44:47], v[92:95]
    s_add_u32 s34, s50, 155648
    buffer_load_dwordx4 v[44:47], v1, s[12:15], s34 offen offset:3072 sc1
    s_waitcnt vmcnt(15)
    v_mfma_f32_16x16x32_bf16 v[80:83], a[160:163], v[48:51], v[80:83]
    v_mfma_f32_16x16x32_bf16 v[84:87], a[164:167], v[48:51], v[84:87]
    s_add_u32 s34, s50, 28672
    buffer_load_dwordx4 v[48:51], v1, s[12:15], s34 offen offset:0 sc1
    s_waitcnt vmcnt(15)
    v_mfma_f32_16x16x32_bf16 v[88:91], a[160:163], v[52:55], v[88:91]
    v_mfma_f32_16x16x32_bf16 v[92:95], a[164:167], v[52:55], v[92:95]
    s_add_u32 s34, s50, 159744
    buffer_load_dwordx4 v[52:55], v1, s[12:15], s34 offen offset:0 sc1
    s_waitcnt vmcnt(15)
    v_mfma_f32_16x16x32_bf16 v[80:83], a[168:171], v[56:59], v[80:83]
    v_mfma_f32_16x16x32_bf16 v[84:87], a[172:175], v[56:59], v[84:87]
    s_add_u32 s34, s50, 28672
    buffer_load_dwordx4 v[56:59], v1, s[12:15], s34 offen offset:1024 sc1
    s_waitcnt vmcnt(15)
    v_mfma_f32_16x16x32_bf16 v[88:91], a[168:171], v[60:63], v[88:91]
    v_mfma_f32_16x16x32_bf16 v[92:95], a[172:175], v[60:63], v[92:95]
    s_add_u32 s34, s50, 159744
    buffer_load_dwordx4 v[60:63], v1, s[12:15], s34 offen offset:1024 sc1
    s_waitcnt vmcnt(15)
    v_mfma_f32_16x16x32_bf16 v[80:83], a[176:179], v[64:67], v[80:83]
    v_mfma_f32_16x16x32_bf16 v[84:87], a[180:183], v[64:67], v[84:87]
    s_add_u32 s34, s50, 28672
    buffer_load_dwordx4 v[64:67], v1, s[12:15], s34 offen offset:2048 sc1
    s_waitcnt vmcnt(15)
    v_mfma_f32_16x16x32_bf16 v[88:91], a[176:179], v[68:71], v[88:91]
    v_mfma_f32_16x16x32_bf16 v[92:95], a[180:183], v[68:71], v[92:95]
    s_add_u32 s34, s50, 159744
    buffer_load_dwordx4 v[68:71], v1, s[12:15], s34 offen offset:2048 sc1
    s_waitcnt vmcnt(15)
    v_mfma_f32_16x16x32_bf16 v[80:83], a[184:187], v[72:75], v[80:83]
    v_mfma_f32_16x16x32_bf16 v[84:87], a[188:191], v[72:75], v[84:87]
    s_add_u32 s34, s50, 28672
    buffer_load_dwordx4 v[72:75], v1, s[12:15], s34 offen offset:3072 sc1
    s_waitcnt vmcnt(15)
    v_mfma_f32_16x16x32_bf16 v[88:91], a[184:187], v[76:79], v[88:91]
    v_mfma_f32_16x16x32_bf16 v[92:95], a[188:191], v[76:79], v[92:95]
    s_add_u32 s34, s50, 159744
    buffer_load_dwordx4 v[76:79], v1, s[12:15], s34 offen offset:3072 sc1
    s_waitcnt vmcnt(15)
    v_mfma_f32_16x16x32_bf16 v[80:83], a[192:195], v[16:19], v[80:83]
    v_mfma_f32_16x16x32_bf16 v[84:87], a[196:199], v[16:19], v[84:87]
    s_waitcnt vmcnt(14)
    v_mfma_f32_16x16x32_bf16 v[88:91], a[192:195], v[20:23], v[88:91]
    v_mfma_f32_16x16x32_bf16 v[92:95], a[196:199], v[20:23], v[92:95]
    s_waitcnt vmcnt(13)
    v_mfma_f32_16x16x32_bf16 v[80:83], a[200:203], v[24:27], v[80:83]
    v_mfma_f32_16x16x32_bf16 v[84:87], a[204:207], v[24:27], v[84:87]
    s_waitcnt vmcnt(12)
    v_mfma_f32_16x16x32_bf16 v[88:91], a[200:203], v[28:31], v[88:91]
    v_mfma_f32_16x16x32_bf16 v[92:95], a[204:207], v[28:31], v[92:95]
    s_waitcnt vmcnt(11)
    v_mfma_f32_16x16x32_bf16 v[80:83], a[208:211], v[32:35], v[80:83]
    v_mfma_f32_16x16x32_bf16 v[84:87], a[212:215], v[32:35], v[84:87]
    s_waitcnt vmcnt(10)
    v_mfma_f32_16x16x32_bf16 v[88:91], a[208:211], v[36:39], v[88:91]
    v_mfma_f32_16x16x32_bf16 v[92:95], a[212:215], v[36:39], v[92:95]
    s_waitcnt vmcnt(9)
    v_mfma_f32_16x16x32_bf16 v[80:83], a[216:219], v[40:43], v[80:83]
    v_mfma_f32_16x16x32_bf16 v[84:87], a[220:223], v[40:43], v[84:87]
    s_waitcnt vmcnt(8)
    v_mfma_f32_16x16x32_bf16 v[88:91], a[216:219], v[44:47], v[88:91]
    v_mfma_f32_16x16x32_bf16 v[92:95], a[220:223], v[44:47], v[92:95]
    s_waitcnt vmcnt(7)
    v_mfma_f32_16x16x32_bf16 v[80:83], a[224:227], v[48:51], v[80:83]
    v_mfma_f32_16x16x32_bf16 v[84:87], a[228:231], v[48:51], v[84:87]
    s_waitcnt vmcnt(6)
    v_mfma_f32_16x16x32_bf16 v[88:91], a[224:227], v[52:55], v[88:91]
    v_mfma_f32_16x16x32_bf16 v[92:95], a[228:231], v[52:55], v[92:95]
    s_waitcnt vmcnt(5)
    v_mfma_f32_16x16x32_bf16 v[80:83], a[232:235], v[56:59], v[80:83]
    v_mfma_f32_16x16x32_bf16 v[84:87], a[236:239], v[56:59], v[84:87]
    s_waitcnt vmcnt(4)
    v_mfma_f32_16x16x32_bf16 v[88:91], a[232:235], v[60:63], v[88:91]
    v_mfma_f32_16x16x32_bf16 v[92:95], a[236:239], v[60:63], v[92:95]
    s_waitcnt vmcnt(3)
    v_mfma_f32_16x16x32_bf16 v[80:83], a[240:243], v[64:67], v[80:83]
    v_mfma_f32_16x16x32_bf16 v[84:87], a[244:247], v[64:67], v[84:87]
    s_waitcnt vmcnt(2)
    v_mfma_f32_16x16x32_bf16 v[88:91], a[240:243], v[68:71], v[88:91]
    v_mfma_f32_16x16x32_bf16 v[92:95], a[244:247], v[68:71], v[92:95]
    s_waitcnt vmcnt(1)
    v_mfma_f32_16x16x32_bf16 v[80:83], a[248:251], v[72:75], v[80:83]
    v_mfma_f32_16x16x32_bf16 v[84:87], a[252:255], v[72:75], v[84:87]
    s_waitcnt vmcnt(0)
    v_mfma_f32_16x16x32_bf16 v[88:91], a[248:251], v[76:79], v[88:91]
    v_mfma_f32_16x16x32_bf16 v[92:95], a[252:255], v[76:79], v[92:95]
    ds_write_b128 v10, v[80:83] offset:0
    ds_write_b128 v10, v[84:87] offset:1024
    s_nop 1
    ds_write_b128 v10, v[88:91] offset:2048
    s_nop 2
    ds_write_b128 v10, v[92:95] offset:3072
    s_waitcnt lgkmcnt(0)
    s_barrier
    ds_read_b128 v[16:19], v11 offset:0
    ds_read_b128 v[20:23], v11 offset:4096
    ds_read_b128 v[24:27], v11 offset:8192
    ds_read_b128 v[28:31], v11 offset:12288
    s_waitcnt lgkmcnt(2)
    v_add_f32 v16, v16, v20
    s_waitcnt lgkmcnt(0)
    v_add_f32 v24, v24, v28
    v_add_f32 v17, v17, v21
    v_add_f32 v25, v25, v29
    v_add_f32 v18, v18, v22
    v_add_f32 v26, v26, v30
    v_add_f32 v19, v19, v23
    v_add_f32 v27, v27, v31
    v_lshlrev_b32 v40, 16, v12
    v_and_b32 v41, 0xffff0000, v12
    v_lshlrev_b32 v42, 16, v13
    v_and_b32 v43, 0xffff0000, v13
    v_add_f32 v16, v16, v24
    v_add_f32 v16, v16, v40
    v_add_f32 v17, v17, v25
    v_add_f32 v17, v17, v41
    v_add_f32 v18, v18, v26
    v_add_f32 v18, v18, v42
    v_add_f32 v19, v19, v27
    v_add_f32 v19, v19, v43
    v_cvt_pk_bf16_f32 v12, v16, v17
    v_cvt_pk_bf16_f32 v13, v18, v19
    buffer_store_dwordx2 v[12:13], v9, s[16:19], s32 offen
    s_waitcnt lgkmcnt(0)
    s_barrier
    s_add_u32 s26, s26, 10
    s_cmp_lt_u32 s26, 64
    s_cbranch_scc1 FN_loop
    s_waitcnt vmcnt(0)
L_end:
    s_endpgm
.section .rodata,"a"
.p2align 6
.amdhsa_kernel parallel_sum__memory_aug_recurrent_mem_tr__dense_activation_mish__prompt_kernel
  .amdhsa_next_free_vgpr 512
  .amdhsa_next_free_sgpr 102
  .amdhsa_accum_offset 256
  .amdhsa_group_segment_fixed_size 0
  .amdhsa_kernarg_size 112
  .amdhsa_user_sgpr_count 2
  .amdhsa_user_sgpr_kernarg_segment_ptr 1
  .amdhsa_system_sgpr_workgroup_id_x 1
.end_amdhsa_kernel
```
